```python
import torch

def _softmax(x, axis=-1):
    return torch.softmax(x, dim=axis)
def _gelu(x):
    return torch.nn.functional.gelu(x, approximate="tanh")
def _silu(x):
    return torch.nn.functional.silu(x)
def _sigmoid(x):
    return torch.sigmoid(x)
def _layernorm(x, axis=-1, eps=1e-5):
    m = x.mean(dim=axis, keepdim=True)
    v = x.var(dim=axis, keepdim=True, unbiased=False)
    return (x - m) / torch.sqrt(v + eps)
def _scatter_add(tgt, idx, src, axis=0):
    return tgt.clone().index_add_(axis, idx, src)
def _segment_sum(src, seg, n):
    out = torch.zeros((n,) + src.shape[1:], dtype=src.dtype)
    return out.index_add_(0, seg, src)
def _pad(x, pw):
    flat = tuple(v for pair in reversed(pw) for v in pair)
    return torch.nn.functional.pad(x, flat)

kernel_name = 'standalone__mpnn_edge_mlp__graph'

def setup_inputs():

    _w = (lambda a: (lambda t: t.to(torch.bfloat16) if t.is_floating_point() else t)(torch.as_tensor(a)))
    N, deg, D, De = 12500, 64, 64, max(4, 1)
    E = N * deg
    return {
        "x": _w((lambda *s: torch.randn(*s, dtype=torch.bfloat16) * 0.05)(N, D)),
        "e_attr": _w((lambda *s: torch.randn(*s, dtype=torch.bfloat16) * 0.4)(E, De)),
        "src": _w((lambda lo, hi, *s: torch.randint(lo, hi, s))(0, N, E).to(torch.int64)),
        "dst": _w((lambda lo, hi, *s: torch.randint(lo, hi, s))(0, N, E).to(torch.int64)),
        "w_msg": _w((lambda *s: torch.randn(*s, dtype=torch.bfloat16) * 0.4)(2 * D + De, D)),
        "w_upd": _w((lambda *s: torch.randn(*s, dtype=torch.bfloat16) * 0.05)(2 * D, D)),
    }

def reference(x, e_attr, src, dst, w_msg, w_upd):
    N, D = x.shape
    m_in = torch.concatenate([x[src], x[dst], e_attr], axis=-1)
    msg = _silu(m_in @ w_msg)
    agg = _segment_sum(msg, dst, N)
    return _silu(torch.concatenate([x, agg], axis=-1) @ w_upd)
```

```asm
; @launch grid=(256,1,1) block=(1024,1,1) lds=163840
.amdgcn_target "amdgcn-amd-amdhsa--gfx950"
.text
.globl standalone__mpnn_edge_mlp__graph_kernel
.p2align 8
.type standalone__mpnn_edge_mlp__graph_kernel,@function
standalone__mpnn_edge_mlp__graph_kernel:
    s_cmp_ge_u32 s2, 256
    s_cbranch_scc1 L_end
    s_load_dwordx4 s[12:15], s[0:1], 16
    s_mul_i32 s61, s2, 12544
    v_and_b32 v2, 63, v0
    v_lshlrev_b32 v7, 1, v0
    s_add_u32 s18, s61, 12544
    v_sub_u32 v7, v7, v2
    s_min_u32 s18, s18, 3200000
    v_lshlrev_b32 v16, 3, v7
    s_mov_b32 s19, 0x20000
    s_getpc_b64 s[4:5]
L_pc:
    v_lshlrev_b32 v100, 6, v0
    v_mov_b32 v101, s5
    v_cmp_gt_u32 vcc, L_last-L_pc, v100
    s_and_saveexec_b64 s[6:7], vcc
    s_cbranch_execz L_nopf
    v_add_co_u32 v100, vcc, s4, v100
    s_nop 1
    v_addc_co_u32 v101, vcc, 0, v101, vcc
    global_load_dword v100, v[100:101], off
L_nopf:
    s_mov_b64 exec, -1
    s_waitcnt lgkmcnt(0)
    s_mov_b64 s[16:17], s[14:15]
    buffer_load_dwordx2 v[8:9], v16, s[16:19], s61 offen
    buffer_load_dwordx2 v[10:11], v16, s[16:19], s61 offen offset:512
    s_mov_b64 s[20:21], s[12:13]
    s_mov_b64 s[22:23], s[18:19]
    s_load_dwordx2 s[24:25], s[0:1], 8
    s_load_dwordx2 s[36:37], s[0:1], 32
    s_load_dwordx2 s[32:33], s[0:1], 0
    s_load_dwordx2 s[40:41], s[0:1], 40
    s_load_dwordx2 s[28:29], s[0:1], 64
    s_load_dwordx2 s[44:45], s[0:1], 48
    v_lshrrev_b32 v1, 6, v0
    v_lshlrev_b32 v30, 2, v0
    v_mov_b32 v32, 0
    v_readfirstlane_b32 s6, v1
    ds_write_b32 v30, v32 offset:59392
    s_sub_u32 s4, s18, s61
    v_add_u32 v17, 0x200, v16
    v_cmp_gt_u32 s[56:57], s4, v16
    v_cmp_gt_u32 s[58:59], s4, v17
    v_lshlrev_b32 v24, 1, v16
    s_lshl_b32 s74, s61, 1
    s_lshl_b32 s26, s18, 1
    s_mov_b32 s27, 0x20000
    s_mov_b32 s38, 16896
    s_mov_b32 s39, 0x20000
    s_mov_b32 s35, 0x20000
    s_mov_b32 s42, 16384
    s_mov_b32 s43, 0x20000
    s_mov_b32 s30, 19103744
    s_mov_b32 s31, 0x20000
    s_and_b32 s7, s2, 7
    s_lshl_b32 s7, s7, 5
    s_lshr_b32 s4, s2, 3
    s_add_u32 s7, s7, s4
    s_mul_i32 s8, s7, 6272
    s_add_u32 s46, s8, 6272
    s_min_u32 s46, s46, 1600000
    s_mov_b32 s34, s46
    s_mov_b32 s47, 0x20000
    v_lshlrev_b32 v31, 4, v2
    v_lshlrev_b32 v41, 4, v7
    v_add_u32 v3, 158720, v31
    s_waitcnt lgkmcnt(0)
    s_cmp_ge_u32 s6, 13
    s_cbranch_scc1 L_loader
    s_barrier
    buffer_load_dwordx2 v[12:13], v16, s[20:23], s61 offen
    buffer_load_dwordx2 v[14:15], v16, s[20:23], s61 offen offset:512
    s_lshl_b32 s4, s6, 11
    s_add_u32 m0, s4, 86528
    s_movk_i32 s60, -49
    v_mov_b32 v17, 1
    s_cmp_lg_u32 s6, 1
    s_cbranch_scc1 L_nocon
    v_lshrrev_b32 v64, 5, v2
    v_bfe_u32 v49, v2, 2, 2
    v_and_b32 v50, 1, v2
    v_bfe_u32 v51, v2, 2, 1
    v_and_b32 v52, 3, v2
    v_lshlrev_b32 v52, 3, v52
    v_and_b32 v53, 15, v2
    v_lshrrev_b32 v54, 4, v2
    v_bfe_u32 v68, v2, 1, 3
    v_xor_b32 v68, v68, v54
    v_lshlrev_b32 v68, 4, v68
    v_lshl_add_u32 v68, v53, 7, v68
    v_lshl_add_u32 v76, v54, 3, v49
    v_lshl_add_u32 v72, v76, 7, v52
    v_bfe_u32 v77, v2, 3, 2
    v_lshl_add_u32 v69, v77, 5, v72
    v_lshlrev_b32 v70, 9, v54
    v_lshl_add_u32 v70, v53, 3, v70
    v_mul_u32_u24 v71, 2688, v54
    v_lshl_add_u32 v71, v53, 2, v71
    ds_write_b128 v3, v[68:71] offset:3072
L_nocon:
    s_add_u32 s48, s28, 4096
    s_addc_u32 s49, s29, 0
    s_mov_b32 s52, s48
    s_mov_b32 s53, s49
    s_or_b32 s49, s49, 0x80000000
    s_mov_b32 s50, 1605632
    s_mov_b32 s51, 0x00c00000
    s_mov_b32 s55, 0x20000
    s_mov_b32 s14, 0
    s_and_b32 s4, s6, 3
    s_bfe_u32 s3, s6, 0x10002
    s_lshl_b32 s63, s4, 11
    s_lshl_b32 s64, s3, 13
    s_add_u32 s64, s64, 113152
    s_mul_i32 s65, s4, 10752
    s_mov_b32 s62, 0xbfb8aa3b
    s_add_u32 s54, s8, 6272
    s_add_u32 s66, s8, s63
    s_waitcnt vmcnt(2)
    v_mul_u32_u24 v32, 21400, v8
    v_lshrrev_b32 v20, 20, v32
    v_lshlrev_b32 v32, 2, v20
    v_mul_u32_u24 v33, 21400, v9
    v_lshrrev_b32 v21, 20, v33
    v_lshlrev_b32 v33, 2, v21
    s_mov_b64 exec, s[56:57]
    ds_add_rtn_u32 v36, v32, v17 offset:59392
    ds_add_rtn_u32 v37, v33, v17 offset:59392
    s_mov_b64 exec, s[58:59]
    v_mul_u32_u24 v34, 21400, v10
    v_lshrrev_b32 v22, 20, v34
    v_lshlrev_b32 v34, 2, v22
    v_mul_u32_u24 v35, 21400, v11
    v_lshrrev_b32 v23, 20, v35
    v_lshlrev_b32 v35, 2, v23
    ds_add_rtn_u32 v38, v34, v17 offset:59392
    ds_add_rtn_u32 v39, v35, v17 offset:59392
    s_mov_b64 exec, -1
    s_cmp_lg_u32 s6, 0
    s_waitcnt lgkmcnt(0)
    s_barrier
    s_cbranch_scc1 L_noscan
    ds_read_b128 v[48:51], v31 offset:59392
    s_waitcnt lgkmcnt(0)
    v_add_u32 v54, v48, v49
    v_add_u32 v55, v54, v50
    v_add_u32 v18, v55, v51
    v_mov_b32 v19, v18
    s_nop 1
    v_add_u32_dpp v19, v19, v19 row_shr:1 row_mask:0xf bank_mask:0xf
    s_nop 1
    v_add_u32_dpp v19, v19, v19 row_shr:2 row_mask:0xf bank_mask:0xf
    s_nop 1
    v_add_u32_dpp v19, v19, v19 row_shr:4 row_mask:0xf bank_mask:0xf
    s_nop 1
    v_add_u32_dpp v19, v19, v19 row_shr:8 row_mask:0xf bank_mask:0xf
    s_nop 1
    v_add_u32_dpp v19, v19, v19 row_bcast:15 row_mask:0xa bank_mask:0xf
    s_nop 1
    v_add_u32_dpp v19, v19, v19 row_bcast:31 row_mask:0xc bank_mask:0xf
    v_sub_u32 v52, v19, v18
    v_add_u32 v53, v52, v48
    v_add_u32 v54, v52, v54
    v_add_u32 v55, v52, v55
    ds_write_b128 v31, v[52:55] offset:60416
    s_waitcnt lgkmcnt(0)
    s_barrier
L_noscan:
    ds_read_b128 v[112:115], v3 offset:3072
    v_add_u32 v47, 87560, v41
    v_add_u32 v45, 87552, v41
    v_add_u32 v43, 86536, v41
    v_mad_i32_i24 v8, v20, s60, v8
    v_mad_i32_i24 v9, v21, s60, v9
    v_mad_i32_i24 v10, v22, s60, v10
    v_mad_i32_i24 v11, v23, s60, v11
    s_waitcnt lgkmcnt(0)
    v_add_u32 v112, s63, v112
    v_add_u32 v113, s64, v113
    v_xor_b32 v116, 64, v112
    v_xor_b32 v117, 32, v113
    v_xor_b32 v118, 64, v113
    v_xor_b32 v119, 0x60, v113
    s_cbranch_scc0 L_scanned
    s_barrier
L_scanned:
    ds_read_b32 v32, v32 offset:60416
    ds_read_b32 v33, v33 offset:60416
    ds_read_b32 v34, v34 offset:60416
    ds_read_b32 v35, v35 offset:60416
    s_mov_b64 exec, -1
    buffer_load_dwordx4 v24, s[24:27], s74 offen lds
    buffer_load_dwordx4 v24, s[24:27], s74 offen offset:1024 lds
    v_add_u32 v41, 86528, v41
    s_waitcnt lgkmcnt(3)
    v_add_lshl_u32 v32, v32, v36, 3
    s_waitcnt lgkmcnt(2)
    v_add_lshl_u32 v33, v33, v37, 3
    s_waitcnt lgkmcnt(1)
    v_add_lshl_u32 v34, v34, v38, 3
    s_waitcnt lgkmcnt(0)
    v_add_lshl_u32 v35, v35, v39, 3
    s_waitcnt vmcnt(2)
    v_lshlrev_b32 v12, 2, v12
    v_lshl_or_b32 v40, v8, 18, v12
    v_lshlrev_b32 v13, 2, v13
    v_lshl_or_b32 v42, v9, 18, v13
    v_lshlrev_b32 v14, 2, v14
    v_lshl_or_b32 v44, v10, 18, v14
    v_lshlrev_b32 v15, 2, v15
    v_lshl_or_b32 v46, v11, 18, v15
    s_mov_b64 exec, s[56:57]
    ds_write_b64 v32, v[40:41] offset:61440
    ds_write_b64 v33, v[42:43] offset:61440
    s_mov_b64 exec, s[58:59]
    ds_write_b64 v34, v[44:45] offset:61440
    ds_write_b64 v35, v[46:47] offset:61440
    s_mov_b64 exec, -1
    s_cmp_lg_u32 s6, 1
    s_cbranch_scc1 L_join
    v_cmp_gt_u32 vcc, 32, v2
    v_mul_u32_u24 v56, 192, v49
    v_add_u32 v56, 57984, v56
    v_and_b32 v55, 1, v54
    v_cndmask_b32 v56, 0, v56, vcc
    v_lshl_add_u32 v55, v55, 5, v52
    v_add_u32 v56, v56, v55
    v_and_b32 v57, 31, v2
    v_lshlrev_b32 v57, 3, v57
    v_bfe_u32 v58, v2, 1, 1
    v_lshl_add_u32 v58, v77, 1, v58
    v_lshlrev_b32 v58, 2, v58
    v_lshlrev_b32 v59, 2, v53
    ds_write_b128 v3, v[56:59]
    v_lshl_add_u32 v66, v51, 1, v50
    v_lshlrev_b32 v63, 3, v66
    v_add_u32 v63, 58464, v63
    v_cndmask_b32 v60, v63, -1, vcc
    v_cmp_eq_u32 vcc, 0, v51
    v_mov_b32 v78, 0x3f80
    v_lshlrev_b32 v79, 4, v50
    v_lshlrev_b32 v79, v79, v78
    v_cndmask_b32 v78, 0, v79, vcc
    v_xor_b32 v79, v78, v79
    ds_write_b64 v63, v[78:79]
    v_mul_u32_u24 v62, 528, v2
    v_add_u32 v62, 59392, v62
    v_mul_u32_u24 v63, 672, v2
    ds_write_b128 v3, v[60:63] offset:1024
    s_mov_b32 s3, 153600
    v_lshl_add_u32 v65, v64, 3, s3
    v_lshl_add_u32 v66, v66, 2, s3
    v_lshl_add_u32 v67, v49, 2, s3
    ds_write_b128 v3, v[64:67] offset:2048
    v_bfe_u32 v73, v2, 3, 1
    v_lshl_add_u32 v73, v73, 2, v54
    v_lshl_add_u32 v73, v51, 5, v73
    v_lshl_add_u32 v73, v73, 7, v52
    v_mul_u32_u24 v74, 672, v53
    v_lshl_add_u32 v74, v54, 4, v74
    ds_write_b128 v3, v[72:75] offset:4096
    v_lshlrev_b32 v77, 2, v2
    ds_write_b32 v77, v62 offset:58176
    v_mov_b32 v32, 0
    v_mov_b32 v33, 0
    v_mov_b32 v34, 0
    v_mov_b32 v35, 0
    ds_write_b128 v32, v[32:35] offset:58432
    s_mov_b64 exec, 0xff
    ds_write_b128 v31, v[32:35] offset:33440
    s_mov_b64 exec, -1
L_join:
    s_barrier
    v_lshlrev_b32 v18, 4, v0
    s_waitcnt lgkmcnt(0)
    s_mov_b32 s10, 0x07060302
    s_cmp_ge_u32 s6, 8
    s_cbranch_scc1 L_nojob
    ds_read_b128 v[56:59], v112 offset:49984
    ds_read_b128 v[60:63], v116 offset:49984
    ds_read_b64_tr_b16 v[64:65], v113 offset:0
    ds_read_b64_tr_b16 v[66:67], v113 offset:512
    ds_read_b64_tr_b16 v[68:69], v113 offset:4096
    ds_read_b64_tr_b16 v[70:71], v113 offset:4608
    ds_read_b64_tr_b16 v[72:73], v117 offset:0
    ds_read_b64_tr_b16 v[74:75], v117 offset:512
    ds_read_b64_tr_b16 v[76:77], v117 offset:4096
    ds_read_b64_tr_b16 v[78:79], v117 offset:4608
    ds_read_b64_tr_b16 v[80:81], v118 offset:0
    ds_read_b64_tr_b16 v[82:83], v118 offset:512
    ds_read_b64_tr_b16 v[84:85], v118 offset:4096
    ds_read_b64_tr_b16 v[86:87], v118 offset:4608
    s_waitcnt lgkmcnt(8)
    ds_read_b64_tr_b16 v[88:89], v119 offset:0
    ds_read_b64_tr_b16 v[90:91], v119 offset:512
    ds_read_b64_tr_b16 v[92:93], v119 offset:4096
    ds_read_b64_tr_b16 v[94:95], v119 offset:4608
    v_mfma_f32_16x16x32_bf16 v[96:99], v[56:59], v[64:67], 0
    v_mfma_f32_16x16x32_bf16 v[96:99], v[60:63], v[68:71], v[96:99]
    s_waitcnt lgkmcnt(8)
    v_mfma_f32_16x16x32_bf16 v[100:103], v[56:59], v[72:75], 0
    v_mfma_f32_16x16x32_bf16 v[100:103], v[60:63], v[76:79], v[100:103]
    s_waitcnt lgkmcnt(4)
    v_mfma_f32_16x16x32_bf16 v[104:107], v[56:59], v[80:83], 0
    v_mfma_f32_16x16x32_bf16 v[104:107], v[60:63], v[84:87], v[104:107]
    s_waitcnt lgkmcnt(0)
    v_mfma_f32_16x16x32_bf16 v[108:111], v[56:59], v[88:91], 0
    v_mfma_f32_16x16x32_bf16 v[108:111], v[60:63], v[92:95], v[108:111]
    s_mov_b32 s3, 0x07060100
    v_mul_f32 v96, s62, v96
    v_mul_f32 v97, s62, v97
    v_mul_f32 v98, s62, v98
    v_mul_f32 v99, s62, v99
    v_mul_f32 v100, s62, v100
    v_mul_f32 v101, s62, v101
    v_mul_f32 v102, s62, v102
    v_mul_f32 v103, s62, v103
    v_mul_f32 v104, s62, v104
    v_mul_f32 v105, s62, v105
    v_mul_f32 v106, s62, v106
    v_mul_f32 v107, s62, v107
    v_mul_f32 v108, s62, v108
    v_mul_f32 v109, s62, v109
    v_mul_f32 v110, s62, v110
    v_mul_f32 v111, s62, v111
    v_cvt_pk_bf16_f32 v64, v96, v104
    v_cvt_pk_bf16_f32 v65, v97, v105
    v_cvt_pk_bf16_f32 v66, v98, v106
    v_cvt_pk_bf16_f32 v67, v99, v107
    s_cmp_ge_u32 s6, 4
    s_cbranch_scc1 L_bt
    v_perm_b32 v56, v100, v64, s3
    v_perm_b32 v57, v108, v64, s10
    v_perm_b32 v58, v101, v65, s3
    v_perm_b32 v59, v109, v65, s10
    v_perm_b32 v60, v102, v66, s3
    v_perm_b32 v61, v110, v66, s10
    v_perm_b32 v62, v103, v67, s3
    v_perm_b32 v63, v111, v67, s10
    s_branch L_jobdone
L_bt:
    v_add_u32 v115, s65, v115
    v_cvt_pk_bf16_f32 v68, v100, v108
    v_cvt_pk_bf16_f32 v69, v101, v109
    v_cvt_pk_bf16_f32 v70, v102, v110
    v_cvt_pk_bf16_f32 v71, v103, v111
    s_cmp_lt_u32 s6, 7
    s_cselect_b64 exec, -1, 0xffff
    ds_write_b32 v115, v64 offset:512
    ds_write_b32 v115, v68 offset:576
    s_cbranch_scc0 L_btdone
    ds_write_b32 v115, v65 offset:1184
    ds_write_b32 v115, v69 offset:1248
    ds_write_b32 v115, v66 offset:1856
    ds_write_b32 v115, v70 offset:1920
    ds_write_b32 v115, v67 offset:2528
    ds_write_b32 v115, v71 offset:2592
L_btdone:
    s_mov_b64 exec, -1
    s_branch L_jobdone
L_nojob:
    v_subrev_u32 v29, 512, v0
    v_lshrrev_b32 v28, 3, v29
    v_cmp_gt_u32 vcc, 50, v28
    v_mul_u32_u24 v28, 672, v28
    v_and_b32 v27, 7, v2
    v_lshl_add_u32 v28, v27, 4, v28
    v_mov_b32 v32, 0
    v_mov_b32 v33, 0
    v_mov_b32 v34, 0
    v_mov_b32 v35, 0
    s_mov_b64 exec, vcc
    ds_write_b128 v28, v[32:35]
    ds_write_b128 v28, v[32:35] offset:128
    ds_write_b128 v28, v[32:35] offset:256
    ds_write_b128 v28, v[32:35] offset:384
    v_cmp_gt_u32 vcc, 320, v29
    v_mov_b32 v36, 85264
    v_mov_b32 v37, v36
    v_mov_b32 v38, 32928
    v_mov_b32 v39, v38
    s_mov_b32 s4, 153600
    v_lshl_add_u32 v29, v29, 3, s4
    s_mov_b64 exec, vcc
    ds_write_b64 v29, v[36:37]
    ds_write_b64 v29, v[38:39] offset:2560
    s_mov_b64 exec, -1
L_jobdone:
    buffer_load_dwordx4 v[20:23], v18, s[40:43], 0 offen
    v_lshlrev_b32 v17, 3, v0
    v_add_u32 v18, 61440, v17
    s_mul_i32 s15, s2, 37760
    s_add_u32 s15, s15, 9437184
    s_add_u32 s4, s15, 4096
    s_add_u32 s5, s15, 8192
    s_add_u32 s56, s15, 12544
    s_add_u32 s57, s56, 8192
    s_add_u32 s58, s56, 16384
    s_cmp_ge_u32 s6, 4
L_w0:
    s_waitcnt vmcnt(0) lgkmcnt(0)
L_w1:
    s_barrier
    ds_read_b64 v[34:35], v18 offset:0
    ds_read_b64 v[38:39], v18 offset:8192
    ds_read_b64 v[42:43], v18 offset:16384
    s_cmp_lg_u32 s6, 15
    s_cbranch_scc1 L_not1
    ds_read_b64 v[46:47], v18 offset:16896
    s_waitcnt lgkmcnt(0)
    ds_read_b64 v[44:45], v47
    buffer_store_dword v46, v30, s[28:31], s5 offen offset:256 sc1
L_not1:
    s_waitcnt lgkmcnt(2)
    ds_read_b64 v[32:33], v35
    buffer_store_dword v34, v30, s[28:31], s15 offen sc1
    s_waitcnt lgkmcnt(2)
    ds_read_b64 v[36:37], v39
    buffer_store_dword v38, v30, s[28:31], s4 offen sc1
    s_waitcnt lgkmcnt(2)
    ds_read_b64 v[40:41], v43
    buffer_store_dword v42, v30, s[28:31], s5 offen sc1
    s_cmp_ge_u32 s6, 4
    s_cbranch_scc1 L_noast5
    buffer_store_dwordx2 v[56:57], v114, s[52:55], s66 offen offset:0 sc1
    buffer_store_dwordx2 v[58:59], v114, s[52:55], s66 offen offset:128 sc1
    buffer_store_dwordx2 v[60:61], v114, s[52:55], s66 offen offset:256 sc1
    buffer_store_dwordx2 v[62:63], v114, s[52:55], s66 offen offset:384 sc1
L_noast5:
    v_mov_b32 v11, 0
    ds_read_b32 v10, v11 offset:58448
    s_cmp_lg_u32 s6, 0
    s_waitcnt lgkmcnt(0)
    v_readfirstlane_b32 s13, v10
    s_cbranch_scc1 L_notabw
    v_mov_b32 v9, v10
    v_mov_b32 v11, v10
    v_mov_b32 v13, v10
    v_mov_b32 v15, v10
    v_lshl_or_b32 v8, v48, 16, v52
    v_lshl_or_b32 v10, v49, 16, v53
    v_lshl_or_b32 v12, v50, 16, v54
    v_lshl_or_b32 v14, v51, 16, v55
    v_and_b32 v16, 7, v2
    v_lshlrev_b32 v16, 4, v16
    v_lshrrev_b32 v19, 3, v2
    v_lshl_add_u32 v16, v19, 16, v16
L_notabw:
    s_lshl_b32 s4, s2, 8
    s_add_u32 s4, s4, 8388608
    s_cmp_lg_u32 s6, 0
    s_waitcnt vmcnt(0)
    s_barrier
    s_cbranch_scc1 L_notab
    buffer_store_dwordx4 v[8:11], v16, s[28:31], s4 offen sc1
    buffer_store_dwordx4 v[12:15], v16, s[28:31], s4 offen offset:128 sc1
L_notab:
    buffer_store_dwordx2 v[32:33], v17, s[28:31], s56 offen sc1
    buffer_store_dwordx2 v[36:37], v17, s[28:31], s57 offen sc1
    buffer_store_dwordx2 v[40:41], v17, s[28:31], s58 offen sc1
    s_cmp_lg_u32 s6, 15
    s_cbranch_scc1 L_notail
    buffer_store_dwordx2 v[44:45], v17, s[28:31], s58 offen offset:512 sc1
L_notail:
    s_cmp_lg_u32 s6, 8
    s_cbranch_scc1 L_now3
    v_lshrrev_b32 v8, 4, v2
    v_and_b32 v9, 15, v2
    v_lshlrev_b32 v10, 7, v8
    v_lshl_add_u32 v10, v9, 1, v10
    v_and_b32 v11, 32, v2
    v_add_u32 v10, v10, v11
    v_add_u32 v10, 129536, v10
    v_xor_b32 v11, 32, v10
    ds_read_u16 v12, v10
    ds_read_u16 v13, v11
    ds_read_u16 v14, v10 offset:64
    ds_read_u16 v15, v11 offset:64
    v_mul_u32_u24 v8, 192, v8
    v_lshl_add_u32 v8, v9, 2, v8
    s_mov_b32 s4, 0xbfb8aa3b
    s_waitcnt lgkmcnt(0)
    v_lshlrev_b32 v12, 16, v12
    v_mul_f32 v12, s4, v12
    v_lshlrev_b32 v13, 16, v13
    v_mul_f32 v13, s4, v13
    v_lshlrev_b32 v14, 16, v14
    v_mul_f32 v14, s4, v14
    v_lshlrev_b32 v15, 16, v15
    v_mul_f32 v15, s4, v15
    v_cvt_pk_bf16_f32 v12, v12, v14
    v_cvt_pk_bf16_f32 v13, v13, v15
    ds_write_b32 v8, v12 offset:58496
    ds_write_b32 v8, v13 offset:58560
L_now3:
    ds_read_b128 v[4:7], v3
    v_lshrrev_b32 v17, 2, v0
    s_mov_b32 s5, 37760
    v_mul_lo_u32 v89, v17, s5
    v_lshlrev_b32 v88, 8, v17
    v_and_b32 v91, 15, v2
    v_lshlrev_b32 v71, 7, v17
    s_and_b32 s74, s2, 7
    s_lshl_b32 s74, s74, 16
    s_bfe_u32 s3, s7, 0x10001
    s_lshl_b32 s3, s3, 7
    s_add_u32 s74, s74, s3
    s_bfe_u32 s3, s7, 0x30002
    s_lshl_b32 s3, s3, 4
    s_add_u32 s74, s74, s3
    s_and_b32 s3, s7, 1
    s_lshl_b32 s3, s3, 3
    s_add_u32 s74, s74, s3
    s_add_u32 s74, s74, 8388608
    s_mov_b32 s75, 0xf000f000
    s_mov_b32 s5, 9437184
    s_cmp_lg_u32 s6, 15
    s_cbranch_scc1 L_filled
    v_lshlrev_b32 v8, 2, v2
    v_add_u32 v8, 85264, v8
    v_mov_b32 v9, 50172
    v_mov_b32 v10, 58432
    ds_write2st64_b32 v8, v9, v10 offset0:0 offset1:104
L_filled:
    s_mov_b64 exec, -1
    ds_read_b128 v[124:127], v3 offset:2048
    ds_read_b128 v[96:99], v3 offset:1024
    s_mul_i32 s11, s6, 2560
    s_add_u32 s11, s11, 112640
    s_mov_b32 m0, s11
    s_mov_b32 s12, 9449728
    s_sub_u32 s20, s12, 1024
    v_and_b32 v16, 48, v2
    v_add_u32 v16, v16, v2
    v_lshl_add_u32 v27, v16, 3, s11
    v_add_u32 v31, 128, v27
    v_add_u32 v35, 1024, v27
    v_add_u32 v39, 1152, v27
    s_lshr_b32 s11, s11, 3
    s_add_u32 s11, s11, 256
    s_add_u32 s21, s11, 64
    s_mov_b32 s9, 0x05040100
    s_mov_b32 s10, 0x07060302
    v_lshrrev_b32 v16, 3, v0
    v_lshlrev_b32 v16, 7, v16
    v_and_b32 v17, 7, v0
    v_lshl_add_u32 v16, v17, 2, v16
    v_add_u32 v16, 33600, v16
    v_perm_b32 v8, v22, v20, s9
    v_perm_b32 v9, v22, v20, s10
    v_perm_b32 v10, v23, v21, s9
    v_perm_b32 v11, v23, v21, s10
    ds_write2_b32 v16, v8, v9 offset0:0 offset1:8
    ds_write2_b32 v16, v10, v11 offset0:16 offset1:24
    v_mov_b32 v19, 0
    v_mov_b32 v20, 4
    v_lshlrev_b32 v18, 2, v2
    v_mov_b32 v118, 0
    s_lshl_b32 s4, s6, 4
    s_lshl_b32 s22, s6, 6
    s_waitcnt lgkmcnt(0)
    v_add_u32 v125, s4, v125
    v_add_u32 v126, s4, v126
    v_add_u32 v127, s4, v127
    v_add_u32 v22, s22, v98
    v_subrev_u32 v98, 28, v98
    v_mov_b32 v122, v96
    v_and_b32 v16, 31, v2
    s_movk_i32 s4, 12500
    v_add_lshl_u32 v16, v16, s4, 2
    v_mov_b32 v17, 58432
    v_lshlrev_b32 v70, 1, v7
    v_and_b32 v68, 7, v2
    v_lshlrev_b32 v69, 4, v68
    v_lshlrev_b32 v68, 1, v68
    s_lshr_b32 s23, s2, 3
    s_lshl_b32 s23, s23, 4
    s_add_u32 s23, s23, s6
    s_mul_i32 s23, s23, 49
    s_lshr_b32 s23, s23, 1
    s_lshl_b32 s23, s23, 7
    s_add_u32 s23, s23, 4096
    v_lshlrev_b32 v72, 7, v2
    s_lshl_b32 s4, s2, 7
    s_add_u32 s4, s4, 7340032
    s_mov_b32 s24, 7340032
    v_mov_b32 v74, s13
    v_not_b32 v75, v74
    v_lshlrev_b32 v73, 3, v2
    s_mov_b32 s3, 0x100000
    s_cmp_lg_u32 s6, 1
    s_waitcnt vmcnt(0) lgkmcnt(0)
    s_barrier
    s_cbranch_scc1 L_nof2
    s_mov_b64 exec, 0xffff
    buffer_store_dwordx2 v[74:75], v73, s[28:31], s4 offen sc1
    s_mov_b64 exec, -1
L_nof2:
L_poll:
    buffer_load_dwordx2 v[92:93], v88, s[28:31], s74 offen sc1
    s_waitcnt vmcnt(0)
L_pchk:
    v_xor_b32 v24, s13, v93
    v_and_or_b32 v24, v92, s75, v24
    v_cmp_ne_u32 vcc, 0, v24
    s_and_b64 exec, exec, vcc
    s_cbranch_scc0 L_polled
    s_sleep 1
    s_sub_u32 s3, s3, 1
    s_cbranch_scc0 L_poll
L_giveup:
    v_mov_b32 v24, 0
    v_mov_b32 v25, 8
    ds_or_b32 v24, v25 offset:58440
    s_endpgm
L_polled:
    s_mov_b64 exec, -1
    v_and_b32 v94, 0xffff, v92
    v_lshrrev_b32 v92, 16, v92
    v_lshl_add_u32 v93, v94, 2, v89
    v_lshl_add_u32 v94, v94, 3, v89
    v_sub_u32_dpp v78, v92, v91 row_newbcast:0 row_mask:0xf bank_mask:0xf
    v_sub_u32_dpp v79, v92, v91 row_newbcast:4 row_mask:0xf bank_mask:0xf
    v_sub_u32_dpp v80, v92, v91 row_newbcast:8 row_mask:0xf bank_mask:0xf
    v_sub_u32_dpp v81, v92, v91 row_newbcast:12 row_mask:0xf bank_mask:0xf
    v_add_u32_dpp v8, v93, v7 row_newbcast:0 row_mask:0xf bank_mask:0xf
    v_cmp_lt_i32 s[56:57], 0, v78
    v_add_u32_dpp v9, v93, v7 row_newbcast:4 row_mask:0xf bank_mask:0xf
    v_cmp_lt_i32 s[58:59], 0, v79
    v_add_u32_dpp v10, v93, v7 row_newbcast:8 row_mask:0xf bank_mask:0xf
    v_cmp_lt_i32 s[60:61], 0, v80
    v_add_u32_dpp v11, v93, v7 row_newbcast:12 row_mask:0xf bank_mask:0xf
    v_cmp_lt_i32 s[62:63], 0, v81
    s_mov_b64 exec, s[56:57]
    buffer_load_dword v26, v8, s[28:31], s5 offen
    s_mov_b64 exec, s[58:59]
    buffer_load_dword v30, v9, s[28:31], s5 offen
    s_mov_b64 exec, s[60:61]
    buffer_load_dword v34, v10, s[28:31], s5 offen
    s_mov_b64 exec, s[62:63]
    buffer_load_dword v38, v11, s[28:31], s5 offen
    s_mov_b64 exec, -1
    v_cmp_lt_u32 s[72:73], 32, v92
    v_cmp_lt_i32 s[64:65], 16, v78
    v_add_u32_dpp v78, v94, v70 row_newbcast:0 row_mask:0xf bank_mask:0xf
    v_cmp_lt_i32 s[66:67], 16, v79
    v_add_u32_dpp v79, v94, v70 row_newbcast:4 row_mask:0xf bank_mask:0xf
    v_cmp_lt_i32 s[68:69], 16, v80
    v_add_u32_dpp v80, v94, v70 row_newbcast:8 row_mask:0xf bank_mask:0xf
    v_cmp_lt_i32 s[70:71], 16, v81
    v_add_u32_dpp v81, v94, v70 row_newbcast:12 row_mask:0xf bank_mask:0xf
    s_mov_b64 exec, s[64:65]
    buffer_load_dword v42, v8, s[28:31], s5 offen offset:64
    s_mov_b64 exec, s[66:67]
    buffer_load_dword v46, v9, s[28:31], s5 offen offset:64
    s_mov_b64 exec, s[68:69]
    buffer_load_dword v50, v10, s[28:31], s5 offen offset:64
    s_mov_b64 exec, s[70:71]
    buffer_load_dword v54, v11, s[28:31], s5 offen offset:64
    s_mov_b64 exec, 0xf
    buffer_load_dword v73, v72, s[28:31], s23 offen offset:0 sc1
    s_mov_b64 exec, -1
    v_add_u32_dpp v56, v94, v69 row_newbcast:0 row_mask:0xf bank_mask:0x3
    v_sub_u32_dpp v58, v92, v68 row_newbcast:0 row_mask:0xf bank_mask:0x3
    v_add_u32_dpp v56, v94, v69 row_newbcast:4 row_mask:0xf bank_mask:0xc
    v_sub_u32_dpp v58, v92, v68 row_newbcast:4 row_mask:0xf bank_mask:0xc
    v_add_u32_dpp v57, v94, v69 row_newbcast:8 row_mask:0xf bank_mask:0x3
    v_sub_u32_dpp v59, v92, v68 row_newbcast:8 row_mask:0xf bank_mask:0x3
    v_add_u32_dpp v57, v94, v69 row_newbcast:12 row_mask:0xf bank_mask:0xc
    v_sub_u32_dpp v59, v92, v68 row_newbcast:12 row_mask:0xf bank_mask:0xc
    v_cmp_lt_i32 s[16:17], 0, v58
    v_cmp_lt_i32 s[18:19], 0, v59
    s_bcnt1_i32_b64 s4, s[64:65]
    s_cbranch_scc0 L_ns0
    v_mbcnt_lo_u32_b32 v43, s64, 0
    v_mbcnt_hi_u32_b32 v43, s65, v43
    v_add_lshl_u32 v43, v43, s11, 3
    s_add_u32 s11, s11, s4
L_ns0:
    s_bcnt1_i32_b64 s4, s[66:67]
    s_cbranch_scc0 L_ns1
    v_mbcnt_lo_u32_b32 v47, s66, 0
    v_mbcnt_hi_u32_b32 v47, s67, v47
    v_add_lshl_u32 v47, v47, s11, 3
    s_add_u32 s11, s11, s4
L_ns1:
    s_bcnt1_i32_b64 s4, s[68:69]
    s_cbranch_scc0 L_ns2
    v_mbcnt_lo_u32_b32 v51, s68, 0
    v_mbcnt_hi_u32_b32 v51, s69, v51
    v_add_lshl_u32 v51, v51, s11, 3
    s_add_u32 s11, s11, s4
L_ns2:
    s_bcnt1_i32_b64 s4, s[70:71]
    s_cbranch_scc0 L_ns3
    v_mbcnt_lo_u32_b32 v55, s70, 0
    v_mbcnt_hi_u32_b32 v55, s71, v55
    v_add_lshl_u32 v55, v55, s11, 3
    s_add_u32 s11, s11, s4
L_ns3:
    s_cmp_gt_u32 s11, s21
    s_mov_b32 s25, s11
    s_cbranch_scc0 L_ok1
    ds_or_b32 v19, v20 offset:58440
    s_mov_b64 s[64:65], 0
    s_mov_b64 s[66:67], 0
    s_mov_b64 s[68:69], 0
    s_mov_b64 s[70:71], 0
    s_mov_b64 s[72:73], 0
L_ok1:
    s_add_u32 s74, s6, 38400
    s_lshl_b32 s75, s6, 2
    s_sub_u32 s75, s75, 36
    s_sub_u32 s11, 28, s75
    s_waitcnt vmcnt(1)
    buffer_load_dwordx2 v[76:77], v71, s[28:31], s24 offen sc1
    s_mov_b64 exec, s[56:57]
    v_lshrrev_b32 v21, 16, v26
    ds_add_rtn_u32 v60, v21, v20 offset:58176
    v_and_b32 v26, 0xffff, v26
    s_mov_b64 exec, s[58:59]
    v_lshrrev_b32 v21, 16, v30
    ds_add_rtn_u32 v61, v21, v20 offset:58176
    v_and_b32 v30, 0xffff, v30
    s_mov_b64 exec, s[60:61]
    v_lshrrev_b32 v21, 16, v34
    ds_add_rtn_u32 v62, v21, v20 offset:58176
    v_and_b32 v34, 0xffff, v34
    s_mov_b64 exec, s[62:63]
    v_lshrrev_b32 v21, 16, v38
    ds_add_rtn_u32 v63, v21, v20 offset:58176
    v_and_b32 v38, 0xffff, v38
    s_mov_b64 exec, s[64:65]
    s_cbranch_execz L_np4
    v_lshrrev_b32 v21, 16, v42
    ds_add_rtn_u32 v64, v21, v20 offset:58176
    v_and_b32 v42, 0xffff, v42
L_np4:
    s_mov_b64 exec, s[66:67]
    s_cbranch_execz L_np5
    v_lshrrev_b32 v21, 16, v46
    ds_add_rtn_u32 v65, v21, v20 offset:58176
    v_and_b32 v46, 0xffff, v46
L_np5:
    s_mov_b64 exec, s[68:69]
    s_cbranch_execz L_np6
    v_lshrrev_b32 v21, 16, v50
    ds_add_rtn_u32 v66, v21, v20 offset:58176
    v_and_b32 v50, 0xffff, v50
L_np6:
    s_mov_b64 exec, s[70:71]
    s_cbranch_execz L_np7
    v_lshrrev_b32 v21, 16, v54
    ds_add_rtn_u32 v67, v21, v20 offset:58176
    v_and_b32 v54, 0xffff, v54
L_np7:
    s_waitcnt lgkmcnt(0)
    s_mov_b64 exec, s[56:57]
    ds_write2st64_b32 v60, v26, v27 offset0:0 offset1:104
    s_mov_b64 exec, s[58:59]
    ds_write2st64_b32 v61, v30, v31 offset0:0 offset1:104
    s_mov_b64 exec, s[60:61]
    ds_write2st64_b32 v62, v34, v35 offset0:0 offset1:104
    s_mov_b64 exec, s[62:63]
    ds_write2st64_b32 v63, v38, v39 offset0:0 offset1:104
    s_mov_b64 exec, s[64:65]
    s_cbranch_execz L_nq4
    ds_write2st64_b32 v64, v42, v43 offset0:0 offset1:104
L_nq4:
    s_mov_b64 exec, s[66:67]
    s_cbranch_execz L_nq5
    ds_write2st64_b32 v65, v46, v47 offset0:0 offset1:104
L_nq5:
    s_mov_b64 exec, s[68:69]
    s_cbranch_execz L_nq6
    ds_write2st64_b32 v66, v50, v51 offset0:0 offset1:104
L_nq6:
    s_mov_b64 exec, s[70:71]
    s_cbranch_execz L_nq7
    ds_write2st64_b32 v67, v54, v55 offset0:0 offset1:104
L_nq7:
    s_cmp_lg_u64 s[72:73], 0
    s_cbranch_scc1 L_long
L_longdone:
    s_cmp_ge_u32 s6, 9
    s_cbranch_scc1 L_ealate
    s_mov_b64 exec, -1
    s_waitcnt vmcnt(0)
L_f2chk:
    v_cmp_ne_u64 vcc, v[74:75], v[76:77]
    s_and_b64 exec, exec, vcc
    s_cbranch_scc0 L_f2ok
    buffer_load_dwordx2 v[76:77], v71, s[28:31], s24 offen sc1
    s_sub_u32 s3, s3, 1
    s_waitcnt vmcnt(0)
    s_cbranch_scc0 L_f2chk
    s_branch L_giveup
L_f2ok:
    s_mov_b64 exec, s[16:17]
    buffer_load_dwordx4 v56, s[28:31], s12 offen lds
    s_mov_b64 exec, s[18:19]
    buffer_load_dwordx4 v57, s[28:31], s20 offen offset:1024 lds
    s_mov_b64 exec, s[64:65]
    s_cbranch_execz L_ne0
    buffer_load_dwordx2 v[40:41], v78, s[28:31], s12 offen offset:128
L_ne0:
    s_mov_b64 exec, s[66:67]
    s_cbranch_execz L_ne1
    buffer_load_dwordx2 v[44:45], v79, s[28:31], s12 offen offset:128
L_ne1:
    s_mov_b64 exec, s[68:69]
    s_cbranch_execz L_ne2
    buffer_load_dwordx2 v[48:49], v80, s[28:31], s12 offen offset:128
L_ne2:
    s_mov_b64 exec, s[70:71]
    s_cbranch_execz L_ne3
    buffer_load_dwordx2 v[52:53], v81, s[28:31], s12 offen offset:128
L_ne3:
L_ealate:
    s_mov_b64 exec, -1
    s_barrier
    ds_read_b32 v11, v18 offset:58176
    ds_read_b32 v9, v19 offset:58440
    s_movk_i32 s5, 540
    s_cmp_gt_u32 s6, 8
    s_waitcnt lgkmcnt(0)
    v_sub_u32 v12, v11, v98
    v_readfirstlane_b32 s4, v9
    v_cmp_lt_u32 s[72:73], s5, v12
    s_cbranch_scc1 L_dpad
    v_lshrrev_b32 v8, 6, v12
    v_bfe_u32 v13, v12, 5, 1
    v_lshl_or_b32 v14, v13, 16, v8
    v_mov_b32 v10, v14
    s_or_b32 s5, s72, s73
    s_or_b32 s5, s4, s5
    s_cbranch_scc1 L_slow
    s_nop 1
    v_add_u32_dpp v10, v10, v10 row_shr:1 row_mask:0xf bank_mask:0xf
    s_nop 1
    v_add_u32_dpp v10, v10, v10 row_shr:2 row_mask:0xf bank_mask:0xf
    s_nop 1
    v_add_u32_dpp v10, v10, v10 row_shr:4 row_mask:0xf bank_mask:0xf
    s_nop 1
    v_add_u32_dpp v10, v10, v10 row_shr:8 row_mask:0xf bank_mask:0xf
    s_nop 1
    v_add_u32_dpp v10, v10, v10 row_bcast:15 row_mask:0xa bank_mask:0xf
    s_nop 1
    v_add_u32_dpp v10, v10, v10 row_bcast:31 row_mask:0xc bank_mask:0xf
    s_cmp_eq_u32 s6, 8
    s_cbranch_scc1 L_dsingle
    v_cmp_lt_u32 vcc, s6, v8
    v_sub_u32 v10, v10, v14
    v_and_b32 v10, 0xffff, v10
    v_add_lshl_u32 v10, v10, s74, 2
    s_mov_b64 exec, vcc
    ds_write2st64_b32 v10, v22, v99 offset0:0 offset1:10
    s_branch L_ddone
L_dpad:
    v_and_b32 v12, 31, v12
    v_add_u32 v11, s75, v11
    v_cmp_gt_i32 vcc, s11, v12
    s_or_b32 s5, s72, s73
    s_or_b32 s5, s4, s5
    s_cbranch_scc1 L_slow
    s_mov_b64 exec, vcc
    ds_write2st64_b32 v11, v16, v17 offset0:0 offset1:104
    s_branch L_ddone
L_dsingle:
    v_readlane_b32 s57, v10, 63
    v_sub_u32 v10, v10, v14
    v_lshl_add_u32 v15, v8, 6, v98
    v_add_u32 v15, 28, v15
    s_add_u32 s57, s57, 0x30003
    s_bfe_u32 s56, s57, 0xe0002
    s_sub_u32 s58, 0, s56
    s_and_b32 s58, s58, 3
    v_lshrrev_b32 v11, 18, v10
    s_sub_u32 s4, 4, s58
    v_cmp_gt_u32 vcc, s58, v11
    v_add_u32 v12, s4, v11
    v_bfe_u32 v10, v10, 16, 2
    v_cndmask_b32 v11, v12, v11, vcc
    v_cmp_eq_u32 vcc, 1, v13
    v_and_b32 v11, 15, v11
    s_add_u32 s4, s56, 9600
    v_add_lshl_u32 v11, v11, s4, 2
    v_add_lshl_u32 v10, v10, v11, 2
    v_mov_b32 v11, s57
    ds_write_b32 v19, v11 offset:58452
    s_mov_b64 exec, vcc
    ds_write2st64_b32 v10, v15, v99 offset0:0 offset1:10
L_ddone:
    s_cmp_lt_u32 s6, 9
    s_cbranch_scc1 L_eadone
    s_mov_b64 exec, -1
    s_waitcnt vmcnt(0)
L_f2chkb:
    v_cmp_ne_u64 vcc, v[74:75], v[76:77]
    s_and_b64 exec, exec, vcc
    s_cbranch_scc0 L_f2okb
    buffer_load_dwordx2 v[76:77], v71, s[28:31], s24 offen sc1
    s_sub_u32 s3, s3, 1
    s_waitcnt vmcnt(0)
    s_cbranch_scc0 L_f2chkb
    s_branch L_giveup
L_f2okb:
    s_mov_b64 exec, s[16:17]
    buffer_load_dwordx4 v56, s[28:31], s12 offen lds
    s_mov_b64 exec, s[18:19]
    buffer_load_dwordx4 v57, s[28:31], s20 offen offset:1024 lds
    s_mov_b64 exec, s[64:65]
    s_cbranch_execz L_neb0
    buffer_load_dwordx2 v[40:41], v78, s[28:31], s12 offen offset:128
L_neb0:
    s_mov_b64 exec, s[66:67]
    s_cbranch_execz L_neb1
    buffer_load_dwordx2 v[44:45], v79, s[28:31], s12 offen offset:128
L_neb1:
    s_mov_b64 exec, s[68:69]
    s_cbranch_execz L_neb2
    buffer_load_dwordx2 v[48:49], v80, s[28:31], s12 offen offset:128
L_neb2:
    s_mov_b64 exec, s[70:71]
    s_cbranch_execz L_neb3
    buffer_load_dwordx2 v[52:53], v81, s[28:31], s12 offen offset:128
L_neb3:
L_eadone:
    s_mov_b64 exec, -1
    s_waitcnt lgkmcnt(0)
    s_barrier
    s_cmp_lt_u32 s6, 4
    s_cbranch_scc1 L_e8c
    s_waitcnt vmcnt(0)
    s_mov_b64 exec, s[64:65]
    ds_write_b64 v43, v[40:41]
    s_mov_b64 exec, s[66:67]
    ds_write_b64 v47, v[44:45]
    s_mov_b64 exec, s[68:69]
    ds_write_b64 v51, v[48:49]
    s_mov_b64 exec, s[70:71]
    ds_write_b64 v55, v[52:53]
    s_mov_b64 exec, -1
    s_waitcnt lgkmcnt(0)
    s_barrier
L_e8c:
    s_setprio 3
    s_cmp_lt_u32 s6, 4
    s_cbranch_scc1 L_gp
    s_setprio 2
    s_cmp_lt_u32 s6, 8
    s_cbranch_scc1 L_gp
    s_setprio 1
    s_cmp_lt_u32 s6, 12
    s_cbranch_scc1 L_gp
    s_setprio 0
L_gp:
    ds_read_b32 v110, v19 offset:58452
    ds_read_b64 v[102:103], v125
    ds_read_b32 v119, v126
    ds_read_b32 v121, v127 offset:2560
    ds_read_b64 v[114:115], v125 offset:256
    s_waitcnt lgkmcnt(2)
    v_add_u32 v119, v119, v6
    ds_read_b128 v[72:75], v102 offset:0
    ds_read_b128 v[76:79], v102 offset:16
    ds_read_b128 v[80:83], v103 offset:0
    ds_read_b128 v[84:87], v103 offset:16
    ds_read_b32 v120, v119 offset:26624
    ds_read_b128 v[56:59], v102 offset:32
    ds_read_b128 v[60:63], v102 offset:48
    ds_read_b128 v[88:91], v103 offset:32
    ds_read_b128 v[92:95], v103 offset:48
    v_readfirstlane_b32 s57, v110
    s_bfe_u32 s56, s57, 0xe0002
    s_lshr_b32 s57, s57, 18
    s_sub_u32 s58, 0, s56
    s_and_b32 s58, s58, 3
    s_add_u32 s12, s56, 15
    s_sub_u32 s12, s12, s6
    s_lshr_b32 s12, s12, 4
    s_lshl_b32 s12, s12, 1
    s_sub_u32 s4, s6, s56
    s_and_b32 s4, s4, 15
    s_add_u32 s5, s4, 12
    s_and_b32 s5, s5, 15
    s_add_u32 s5, s5, s58
    s_cmp_lt_u32 s4, s58
    s_cselect_b32 s5, s4, s5
    s_cmp_lt_u32 s5, s57
    s_addc_u32 s12, s12, 0
    s_cmp_eq_u32 s12, 0
    s_cbranch_scc1 L_zero
    s_waitcnt lgkmcnt(4)
    v_mad_u32_u24 v121, v121, v124, v4
    s_cmp_lt_u32 s6, 4
    buffer_load_dword v8, v72, s[48:51], 0 offen sc1
    buffer_load_dword v10, v73, s[48:51], 0 offen sc1
    buffer_load_dword v12, v74, s[48:51], 0 offen sc1
    buffer_load_dword v14, v75, s[48:51], 0 offen sc1
    buffer_load_dword v16, v76, s[48:51], 0 offen sc1
    buffer_load_dword v18, v77, s[48:51], 0 offen sc1
    buffer_load_dword v20, v78, s[48:51], 0 offen sc1
    buffer_load_dword v22, v79, s[48:51], 0 offen sc1
    buffer_load_dword v9, v80, s[48:51], 0 offen sc1
    buffer_load_dword v11, v81, s[48:51], 0 offen sc1
    buffer_load_dword v13, v82, s[48:51], 0 offen sc1
    buffer_load_dword v15, v83, s[48:51], 0 offen sc1
    buffer_load_dword v17, v84, s[48:51], 0 offen sc1
    buffer_load_dword v19, v85, s[48:51], 0 offen sc1
    buffer_load_dword v21, v86, s[48:51], 0 offen sc1
    buffer_load_dword v23, v87, s[48:51], 0 offen sc1
    s_cbranch_scc0 L_e8b
    s_waitcnt vmcnt(16)
    s_mov_b64 exec, s[64:65]
    ds_write_b64 v43, v[40:41]
    s_mov_b64 exec, s[66:67]
    ds_write_b64 v47, v[44:45]
    s_mov_b64 exec, s[68:69]
    ds_write_b64 v51, v[48:49]
    s_mov_b64 exec, s[70:71]
    ds_write_b64 v55, v[52:53]
    s_mov_b64 exec, -1
    s_waitcnt lgkmcnt(0)
    s_barrier
L_e8b:
    v_min_u32 v120, v120, v122
    ds_read_b64 v[96:97], v120
    ds_read_b64_tr_b16 v[98:99], v121 offset:512
    ds_read_b64_tr_b16 v[100:101], v121 offset:576
    ds_read_b32 v120, v119 offset:26656
    ds_read_b32 v119, v126 offset:256
    s_cmp_lt_u32 s12, 2
    s_cbranch_scc1 L_pro1
    s_waitcnt lgkmcnt(7)
    buffer_load_dword v24, v56, s[48:51], 0 offen sc1
    buffer_load_dword v26, v57, s[48:51], 0 offen sc1
    buffer_load_dword v28, v58, s[48:51], 0 offen sc1
    buffer_load_dword v30, v59, s[48:51], 0 offen sc1
    buffer_load_dword v32, v60, s[48:51], 0 offen sc1
    buffer_load_dword v34, v61, s[48:51], 0 offen sc1
    buffer_load_dword v36, v62, s[48:51], 0 offen sc1
    buffer_load_dword v38, v63, s[48:51], 0 offen sc1
    s_waitcnt vmcnt(8)
    s_branch L_pro2
L_pro1:
    s_waitcnt vmcnt(0)
L_pro2:
    v_lshlrev_b64 v[40:41], 16, v[8:9]
    v_lshlrev_b64 v[42:43], 16, v[10:11]
    v_lshlrev_b64 v[44:45], 16, v[12:13]
    v_lshlrev_b64 v[46:47], 16, v[14:15]
    v_lshlrev_b64 v[48:49], 16, v[16:17]
    v_lshlrev_b64 v[50:51], 16, v[18:19]
    v_lshlrev_b64 v[52:53], 16, v[20:21]
    v_lshlrev_b64 v[54:55], 16, v[22:23]
    s_waitcnt lgkmcnt(2)
    v_mfma_f32_32x32x8_bf16 v[8:23], v[96:97], v[100:101], v[8:23]
    v_mov_b32 v84, 0
    v_mov_b32 v85, 0
    v_mov_b32 v86, 0
    v_mov_b32 v87, 0
    v_mov_b32 v116, v5
    v_mov_b32 v117, v5
    v_mfma_f32_32x32x8_bf16 v[40:55], v[96:97], v[98:99], v[40:55]
    s_nop 4
    s_cbranch_scc1 L_single
    s_setprio 2
    .p2align 6
L_loop:
    v_exp_f32 v72, v8
    v_exp_f32 v73, v9
    v_exp_f32 v74, v10
    v_exp_f32 v75, v11
    v_exp_f32 v76, v12
    v_exp_f32 v77, v13
    v_exp_f32 v78, v14
    v_exp_f32 v79, v15
    v_exp_f32 v80, v16
    s_waitcnt lgkmcnt(0)
    ds_add_f64 v116, v[84:85] offset:0
    ds_add_f64 v117, v[86:87] offset:0
    v_min_u32 v120, v120, v122
    ds_read_b64 v[96:97], v120
    buffer_load_dword v25, v88, s[48:51], 0 offen sc1
    buffer_load_dword v27, v89, s[48:51], 0 offen sc1
    buffer_load_dword v29, v90, s[48:51], 0 offen sc1
    buffer_load_dword v31, v91, s[48:51], 0 offen sc1
    buffer_load_dword v33, v92, s[48:51], 0 offen sc1
    buffer_load_dword v35, v93, s[48:51], 0 offen sc1
    buffer_load_dword v37, v94, s[48:51], 0 offen sc1
    buffer_load_dword v39, v95, s[48:51], 0 offen sc1
    ds_read_b128 v[88:91], v114 offset:0
    ds_read_b128 v[92:95], v114 offset:16
    v_exp_f32 v81, v17
    v_exp_f32 v82, v18
    v_exp_f32 v83, v19
    v_exp_f32 v84, v20
    v_exp_f32 v85, v21
    v_exp_f32 v86, v22
    v_exp_f32 v87, v23
    v_pk_add_f32 v[110:111], v[72:73], 1.0 op_sel_hi:[1,0]
    v_pk_fma_f32 v[102:103], v[8:9], v[74:75], v[8:9]
    v_pk_fma_f32 v[112:113], v[110:111], v[74:75], v[110:111]
    v_pk_fma_f32 v[102:103], v[10:11], v[110:111], v[102:103]
    v_pk_fma_f32 v[102:103], v[102:103], v[76:77], v[102:103]
    v_pk_fma_f32 v[110:111], v[112:113], v[76:77], v[112:113]
    v_pk_fma_f32 v[102:103], v[12:13], v[112:113], v[102:103]
    v_pk_fma_f32 v[102:103], v[102:103], v[78:79], v[102:103]
    v_pk_fma_f32 v[112:113], v[110:111], v[78:79], v[110:111]
    v_pk_fma_f32 v[102:103], v[14:15], v[110:111], v[102:103]
    v_pk_fma_f32 v[102:103], v[102:103], v[80:81], v[102:103]
    v_pk_fma_f32 v[110:111], v[112:113], v[80:81], v[112:113]
    v_pk_fma_f32 v[102:103], v[16:17], v[112:113], v[102:103]
    v_pk_fma_f32 v[102:103], v[102:103], v[82:83], v[102:103]
    v_pk_fma_f32 v[112:113], v[110:111], v[82:83], v[110:111]
    v_pk_fma_f32 v[102:103], v[18:19], v[110:111], v[102:103]
    v_pk_fma_f32 v[102:103], v[102:103], v[84:85], v[102:103]
    v_pk_fma_f32 v[110:111], v[112:113], v[84:85], v[112:113]
    v_pk_fma_f32 v[102:103], v[20:21], v[112:113], v[102:103]
    v_pk_fma_f32 v[102:103], v[102:103], v[86:87], v[102:103]
    v_pk_fma_f32 v[106:107], v[110:111], v[86:87], v[110:111]
    v_pk_fma_f32 v[102:103], v[22:23], v[110:111], v[102:103]
    s_waitcnt vmcnt(0) lgkmcnt(0)
    v_lshlrev_b64 v[56:57], 16, v[24:25]
    v_lshlrev_b64 v[58:59], 16, v[26:27]
    v_lshlrev_b64 v[60:61], 16, v[28:29]
    v_lshlrev_b64 v[62:63], 16, v[30:31]
    v_lshlrev_b64 v[64:65], 16, v[32:33]
    v_lshlrev_b64 v[66:67], 16, v[34:35]
    v_lshlrev_b64 v[68:69], 16, v[36:37]
    v_lshlrev_b64 v[70:71], 16, v[38:39]
    v_mfma_f32_32x32x8_bf16 v[24:39], v[96:97], v[100:101], v[24:39]
    v_exp_f32 v72, v40
    v_exp_f32 v73, v41
    v_exp_f32 v74, v42
    v_exp_f32 v75, v43
    v_mfma_f32_32x32x8_bf16 v[56:71], v[96:97], v[98:99], v[56:71]
    v_exp_f32 v76, v44
    v_exp_f32 v77, v45
    v_exp_f32 v78, v46
    v_exp_f32 v79, v47
    v_exp_f32 v80, v48
    v_add_u32 v119, v119, v6
    v_exp_f32 v81, v49
    v_exp_f32 v82, v50
    s_cmp_lt_u32 s12, 3
    s_cbranch_scc1 L_c0
    buffer_load_dword v8, v88, s[48:51], 0 offen sc1
    buffer_load_dword v10, v89, s[48:51], 0 offen sc1
    buffer_load_dword v12, v90, s[48:51], 0 offen sc1
    buffer_load_dword v14, v91, s[48:51], 0 offen sc1
    buffer_load_dword v16, v92, s[48:51], 0 offen sc1
    buffer_load_dword v18, v93, s[48:51], 0 offen sc1
    buffer_load_dword v20, v94, s[48:51], 0 offen sc1
    buffer_load_dword v22, v95, s[48:51], 0 offen sc1
    s_branch L_d0
L_c0:
    s_setprio 1
L_d0:
    ds_read_b128 v[88:91], v115 offset:0
    ds_read_b128 v[92:95], v115 offset:16
    ds_read_b32 v120, v119 offset:26624
    ds_read_b32 v121, v127 offset:2816
    v_exp_f32 v83, v51
    v_exp_f32 v84, v52
    v_exp_f32 v85, v53
    v_exp_f32 v86, v54
    v_exp_f32 v87, v55
    v_pk_add_f32 v[110:111], v[72:73], 1.0 op_sel_hi:[1,0]
    v_pk_fma_f32 v[104:105], v[40:41], v[74:75], v[40:41]
    v_pk_fma_f32 v[112:113], v[110:111], v[74:75], v[110:111]
    v_pk_fma_f32 v[104:105], v[42:43], v[110:111], v[104:105]
    v_pk_fma_f32 v[104:105], v[104:105], v[76:77], v[104:105]
    v_pk_fma_f32 v[110:111], v[112:113], v[76:77], v[112:113]
    v_pk_fma_f32 v[104:105], v[44:45], v[112:113], v[104:105]
    v_pk_fma_f32 v[104:105], v[104:105], v[78:79], v[104:105]
    v_pk_fma_f32 v[112:113], v[110:111], v[78:79], v[110:111]
    v_pk_fma_f32 v[104:105], v[46:47], v[110:111], v[104:105]
    v_pk_fma_f32 v[104:105], v[104:105], v[80:81], v[104:105]
    v_pk_fma_f32 v[110:111], v[112:113], v[80:81], v[112:113]
    v_pk_fma_f32 v[104:105], v[48:49], v[112:113], v[104:105]
    v_pk_fma_f32 v[104:105], v[104:105], v[82:83], v[104:105]
    v_pk_fma_f32 v[112:113], v[110:111], v[82:83], v[110:111]
    v_pk_fma_f32 v[104:105], v[50:51], v[110:111], v[104:105]
    v_pk_fma_f32 v[104:105], v[104:105], v[84:85], v[104:105]
    v_pk_fma_f32 v[110:111], v[112:113], v[84:85], v[112:113]
    v_pk_fma_f32 v[104:105], v[52:53], v[112:113], v[104:105]
    v_pk_fma_f32 v[104:105], v[104:105], v[86:87], v[104:105]
    v_pk_fma_f32 v[108:109], v[110:111], v[86:87], v[110:111]
    v_pk_fma_f32 v[104:105], v[54:55], v[110:111], v[104:105]
    v_exp_f32 v72, v24
    v_exp_f32 v73, v25
    v_exp_f32 v74, v26
    v_exp_f32 v75, v27
    v_exp_f32 v76, v28
    v_exp_f32 v77, v29
    v_exp_f32 v78, v30
    v_exp_f32 v79, v31
    v_exp_f32 v80, v32
    s_waitcnt lgkmcnt(0)
    v_mad_u32_u24 v121, v121, v124, v4
    ds_read_b64 v[116:117], v125 offset:2560
    s_cmp_lt_u32 s12, 3
    s_cbranch_scc1 L_a1
    v_min_u32 v120, v120, v122
    ds_read_b64 v[96:97], v120
    ds_read_b64_tr_b16 v[98:99], v121 offset:512
    ds_read_b64_tr_b16 v[100:101], v121 offset:576
    buffer_load_dword v9, v88, s[48:51], 0 offen sc1
    buffer_load_dword v11, v89, s[48:51], 0 offen sc1
    buffer_load_dword v13, v90, s[48:51], 0 offen sc1
    buffer_load_dword v15, v91, s[48:51], 0 offen sc1
    buffer_load_dword v17, v92, s[48:51], 0 offen sc1
    buffer_load_dword v19, v93, s[48:51], 0 offen sc1
    buffer_load_dword v21, v94, s[48:51], 0 offen sc1
    buffer_load_dword v23, v95, s[48:51], 0 offen sc1
    ds_read_b128 v[88:91], v114 offset:32
    ds_read_b128 v[92:95], v114 offset:48
L_a1:
    v_exp_f32 v81, v33
    v_exp_f32 v82, v34
    v_exp_f32 v83, v35
    v_exp_f32 v84, v36
    v_exp_f32 v85, v37
    v_exp_f32 v86, v38
    v_exp_f32 v87, v39
    v_pk_fma_f32 v[102:103], v[102:103], v[72:73], v[102:103]
    v_pk_fma_f32 v[110:111], v[106:107], v[72:73], v[106:107]
    v_pk_fma_f32 v[102:103], v[24:25], v[106:107], v[102:103]
    v_pk_fma_f32 v[102:103], v[102:103], v[74:75], v[102:103]
    v_pk_fma_f32 v[112:113], v[110:111], v[74:75], v[110:111]
    v_pk_fma_f32 v[102:103], v[26:27], v[110:111], v[102:103]
    v_pk_fma_f32 v[102:103], v[102:103], v[76:77], v[102:103]
    v_pk_fma_f32 v[110:111], v[112:113], v[76:77], v[112:113]
    v_pk_fma_f32 v[102:103], v[28:29], v[112:113], v[102:103]
    v_pk_fma_f32 v[102:103], v[102:103], v[78:79], v[102:103]
    v_pk_fma_f32 v[112:113], v[110:111], v[78:79], v[110:111]
    v_pk_fma_f32 v[102:103], v[30:31], v[110:111], v[102:103]
    v_pk_fma_f32 v[102:103], v[102:103], v[80:81], v[102:103]
    v_pk_fma_f32 v[110:111], v[112:113], v[80:81], v[112:113]
    v_pk_fma_f32 v[102:103], v[32:33], v[112:113], v[102:103]
    v_pk_fma_f32 v[102:103], v[102:103], v[82:83], v[102:103]
    v_pk_fma_f32 v[112:113], v[110:111], v[82:83], v[110:111]
    v_pk_fma_f32 v[102:103], v[34:35], v[110:111], v[102:103]
    v_pk_fma_f32 v[102:103], v[102:103], v[84:85], v[102:103]
    v_pk_fma_f32 v[110:111], v[112:113], v[84:85], v[112:113]
    v_pk_fma_f32 v[102:103], v[36:37], v[112:113], v[102:103]
    v_pk_fma_f32 v[102:103], v[102:103], v[86:87], v[102:103]
    v_pk_fma_f32 v[106:107], v[110:111], v[86:87], v[110:111]
    v_pk_fma_f32 v[102:103], v[38:39], v[110:111], v[102:103]
    v_rcp_f32 v112, v106
    v_rcp_f32 v113, v107
    v_max3_f32 v118, v106, v107, v118
    v_pk_mul_f32 v[112:113], v[102:103], v[112:113]
    v_cvt_f64_f32 v[84:85], v112
    v_cvt_f64_f32 v[86:87], v113
    s_waitcnt vmcnt(0) lgkmcnt(0)
    s_cbranch_scc1 L_last1
    v_lshlrev_b64 v[40:41], 16, v[8:9]
    v_lshlrev_b64 v[42:43], 16, v[10:11]
    v_lshlrev_b64 v[44:45], 16, v[12:13]
    v_lshlrev_b64 v[46:47], 16, v[14:15]
    v_lshlrev_b64 v[48:49], 16, v[16:17]
    v_lshlrev_b64 v[50:51], 16, v[18:19]
    v_lshlrev_b64 v[52:53], 16, v[20:21]
    v_lshlrev_b64 v[54:55], 16, v[22:23]
    v_mfma_f32_32x32x8_bf16 v[8:23], v[96:97], v[100:101], v[8:23]
    v_exp_f32 v72, v56
    v_exp_f32 v73, v57
    v_exp_f32 v74, v58
    v_exp_f32 v75, v59
    v_mfma_f32_32x32x8_bf16 v[40:55], v[96:97], v[98:99], v[40:55]
    v_exp_f32 v76, v60
    v_exp_f32 v77, v61
    v_exp_f32 v78, v62
    v_exp_f32 v79, v63
    v_exp_f32 v80, v64
    v_add_u32 v116, v116, v5
    v_add_u32 v117, v117, v5
    v_exp_f32 v81, v65
    v_exp_f32 v82, v66
    ds_add_f64 v116, v[84:85] offset:256
    ds_add_f64 v117, v[86:87] offset:256
    s_cmp_lt_u32 s12, 4
    s_cbranch_scc1 L_c1
    buffer_load_dword v24, v88, s[48:51], 0 offen sc1
    buffer_load_dword v26, v89, s[48:51], 0 offen sc1
    buffer_load_dword v28, v90, s[48:51], 0 offen sc1
    buffer_load_dword v30, v91, s[48:51], 0 offen sc1
    buffer_load_dword v32, v92, s[48:51], 0 offen sc1
    buffer_load_dword v34, v93, s[48:51], 0 offen sc1
    buffer_load_dword v36, v94, s[48:51], 0 offen sc1
    buffer_load_dword v38, v95, s[48:51], 0 offen sc1
    s_branch L_d1
L_c1:
    s_setprio 1
L_d1:
    ds_read_b128 v[88:91], v115 offset:32
    ds_read_b128 v[92:95], v115 offset:48
    ds_read_b32 v120, v119 offset:26656
    ds_read_b64 v[114:115], v125 offset:512
    ds_read_b32 v119, v126 offset:512
    s_sub_u32 s12, s12, 2
    s_cmp_gt_u32 s12, 1
    v_exp_f32 v83, v67
    v_exp_f32 v84, v68
    v_exp_f32 v85, v69
    v_exp_f32 v86, v70
    v_exp_f32 v87, v71
    v_add_u32 v125, 0x100, v125
    v_add_u32 v126, 0x100, v126
    v_add_u32 v127, 0x100, v127
    v_pk_fma_f32 v[104:105], v[104:105], v[72:73], v[104:105]
    v_pk_fma_f32 v[110:111], v[108:109], v[72:73], v[108:109]
    v_pk_fma_f32 v[104:105], v[56:57], v[108:109], v[104:105]
    v_pk_fma_f32 v[104:105], v[104:105], v[74:75], v[104:105]
    v_pk_fma_f32 v[112:113], v[110:111], v[74:75], v[110:111]
    v_pk_fma_f32 v[104:105], v[58:59], v[110:111], v[104:105]
    v_pk_fma_f32 v[104:105], v[104:105], v[76:77], v[104:105]
    v_pk_fma_f32 v[110:111], v[112:113], v[76:77], v[112:113]
    v_pk_fma_f32 v[104:105], v[60:61], v[112:113], v[104:105]
    v_pk_fma_f32 v[104:105], v[104:105], v[78:79], v[104:105]
    v_pk_fma_f32 v[112:113], v[110:111], v[78:79], v[110:111]
    v_pk_fma_f32 v[104:105], v[62:63], v[110:111], v[104:105]
    v_pk_fma_f32 v[104:105], v[104:105], v[80:81], v[104:105]
    v_pk_fma_f32 v[110:111], v[112:113], v[80:81], v[112:113]
    v_pk_fma_f32 v[104:105], v[64:65], v[112:113], v[104:105]
    v_pk_fma_f32 v[104:105], v[104:105], v[82:83], v[104:105]
    v_pk_fma_f32 v[112:113], v[110:111], v[82:83], v[110:111]
    v_pk_fma_f32 v[104:105], v[66:67], v[110:111], v[104:105]
    v_pk_fma_f32 v[104:105], v[104:105], v[84:85], v[104:105]
    v_pk_fma_f32 v[110:111], v[112:113], v[84:85], v[112:113]
    v_pk_fma_f32 v[104:105], v[68:69], v[112:113], v[104:105]
    v_pk_fma_f32 v[104:105], v[104:105], v[86:87], v[104:105]
    v_pk_fma_f32 v[108:109], v[110:111], v[86:87], v[110:111]
    v_pk_fma_f32 v[104:105], v[70:71], v[110:111], v[104:105]
    v_rcp_f32 v112, v108
    v_rcp_f32 v113, v109
    v_max3_f32 v118, v108, v109, v118
    v_pk_mul_f32 v[112:113], v[104:105], v[112:113]
    v_cvt_f64_f32 v[84:85], v112
    v_cvt_f64_f32 v[86:87], v113
    s_cbranch_scc1 L_loop
L_single:
    s_setprio 1
    v_exp_f32 v72, v8
    v_exp_f32 v73, v9
    v_exp_f32 v74, v10
    v_exp_f32 v75, v11
    ds_add_f64 v116, v[84:85] offset:0
    ds_add_f64 v117, v[86:87] offset:0
    ds_read_b64 v[116:117], v125 offset:2560
    v_exp_f32 v76, v12
    v_exp_f32 v77, v13
    v_exp_f32 v78, v14
    v_exp_f32 v79, v15
    v_exp_f32 v80, v16
    v_exp_f32 v81, v17
    v_exp_f32 v82, v18
    v_exp_f32 v83, v19
    v_exp_f32 v84, v20
    v_exp_f32 v85, v21
    v_exp_f32 v86, v22
    v_exp_f32 v87, v23
    v_pk_add_f32 v[110:111], v[72:73], 1.0 op_sel_hi:[1,0]
    v_pk_fma_f32 v[102:103], v[8:9], v[74:75], v[8:9]
    v_pk_fma_f32 v[112:113], v[110:111], v[74:75], v[110:111]
    v_pk_fma_f32 v[102:103], v[10:11], v[110:111], v[102:103]
    v_pk_fma_f32 v[102:103], v[102:103], v[76:77], v[102:103]
    v_pk_fma_f32 v[110:111], v[112:113], v[76:77], v[112:113]
    v_pk_fma_f32 v[102:103], v[12:13], v[112:113], v[102:103]
    v_pk_fma_f32 v[102:103], v[102:103], v[78:79], v[102:103]
    v_pk_fma_f32 v[112:113], v[110:111], v[78:79], v[110:111]
    v_pk_fma_f32 v[102:103], v[14:15], v[110:111], v[102:103]
    v_pk_fma_f32 v[102:103], v[102:103], v[80:81], v[102:103]
    v_pk_fma_f32 v[110:111], v[112:113], v[80:81], v[112:113]
    v_pk_fma_f32 v[102:103], v[16:17], v[112:113], v[102:103]
    v_pk_fma_f32 v[102:103], v[102:103], v[82:83], v[102:103]
    v_pk_fma_f32 v[112:113], v[110:111], v[82:83], v[110:111]
    v_pk_fma_f32 v[102:103], v[18:19], v[110:111], v[102:103]
    v_pk_fma_f32 v[102:103], v[102:103], v[84:85], v[102:103]
    v_pk_fma_f32 v[110:111], v[112:113], v[84:85], v[112:113]
    v_pk_fma_f32 v[102:103], v[20:21], v[112:113], v[102:103]
    v_pk_fma_f32 v[102:103], v[102:103], v[86:87], v[102:103]
    v_pk_fma_f32 v[106:107], v[110:111], v[86:87], v[110:111]
    v_pk_fma_f32 v[102:103], v[22:23], v[110:111], v[102:103]
    v_rcp_f32 v112, v106
    v_rcp_f32 v113, v107
    v_max3_f32 v118, v106, v107, v118
    v_pk_mul_f32 v[112:113], v[102:103], v[112:113]
    v_cvt_f64_f32 v[84:85], v112
    v_cvt_f64_f32 v[86:87], v113
    s_waitcnt lgkmcnt(0)
    s_cmp_lt_u32 s6, 4
    s_cbranch_scc1 L_lpa
    s_setprio 0
L_lpa:
    v_add_u32 v116, v116, v5
    v_add_u32 v117, v117, v5
    ds_add_f64 v116, v[84:85] offset:256
    ds_add_f64 v117, v[86:87] offset:256
    v_exp_f32 v72, v40
    v_exp_f32 v73, v41
    v_exp_f32 v74, v42
    v_exp_f32 v75, v43
    v_exp_f32 v76, v44
    v_exp_f32 v77, v45
    v_exp_f32 v78, v46
    v_exp_f32 v79, v47
    v_exp_f32 v80, v48
    v_exp_f32 v81, v49
    v_exp_f32 v82, v50
    v_exp_f32 v83, v51
    v_exp_f32 v84, v52
    v_exp_f32 v85, v53
    v_exp_f32 v86, v54
    v_exp_f32 v87, v55
    v_pk_add_f32 v[110:111], v[72:73], 1.0 op_sel_hi:[1,0]
    v_pk_fma_f32 v[104:105], v[40:41], v[74:75], v[40:41]
    v_pk_fma_f32 v[112:113], v[110:111], v[74:75], v[110:111]
    v_pk_fma_f32 v[104:105], v[42:43], v[110:111], v[104:105]
    v_pk_fma_f32 v[104:105], v[104:105], v[76:77], v[104:105]
    v_pk_fma_f32 v[110:111], v[112:113], v[76:77], v[112:113]
    v_pk_fma_f32 v[104:105], v[44:45], v[112:113], v[104:105]
    v_pk_fma_f32 v[104:105], v[104:105], v[78:79], v[104:105]
    v_pk_fma_f32 v[112:113], v[110:111], v[78:79], v[110:111]
    v_pk_fma_f32 v[104:105], v[46:47], v[110:111], v[104:105]
    v_pk_fma_f32 v[104:105], v[104:105], v[80:81], v[104:105]
    v_pk_fma_f32 v[110:111], v[112:113], v[80:81], v[112:113]
    v_pk_fma_f32 v[104:105], v[48:49], v[112:113], v[104:105]
    v_pk_fma_f32 v[104:105], v[104:105], v[82:83], v[104:105]
    v_pk_fma_f32 v[112:113], v[110:111], v[82:83], v[110:111]
    v_pk_fma_f32 v[104:105], v[50:51], v[110:111], v[104:105]
    v_pk_fma_f32 v[104:105], v[104:105], v[84:85], v[104:105]
    v_pk_fma_f32 v[110:111], v[112:113], v[84:85], v[112:113]
    v_pk_fma_f32 v[104:105], v[52:53], v[112:113], v[104:105]
    v_pk_fma_f32 v[104:105], v[104:105], v[86:87], v[104:105]
    v_pk_fma_f32 v[108:109], v[110:111], v[86:87], v[110:111]
    v_pk_fma_f32 v[104:105], v[54:55], v[110:111], v[104:105]
    v_rcp_f32 v112, v108
    v_rcp_f32 v113, v109
    v_max3_f32 v118, v108, v109, v118
    v_pk_mul_f32 v[112:113], v[104:105], v[112:113]
    v_cvt_f64_f32 v[84:85], v112
    v_cvt_f64_f32 v[86:87], v113
    s_branch L_done
L_last1:
    s_cmp_lt_u32 s6, 4
    s_cbranch_scc1 L_lpb
    s_setprio 0
L_lpb:
    v_add_u32 v116, v116, v5
    v_add_u32 v117, v117, v5
    ds_add_f64 v116, v[84:85] offset:256
    ds_add_f64 v117, v[86:87] offset:256
    v_exp_f32 v72, v56
    v_exp_f32 v73, v57
    v_exp_f32 v74, v58
    v_exp_f32 v75, v59
    v_exp_f32 v76, v60
    v_exp_f32 v77, v61
    v_exp_f32 v78, v62
    v_exp_f32 v79, v63
    v_exp_f32 v80, v64
    v_exp_f32 v81, v65
    v_exp_f32 v82, v66
    v_exp_f32 v83, v67
    v_exp_f32 v84, v68
    v_exp_f32 v85, v69
    v_exp_f32 v86, v70
    v_exp_f32 v87, v71
    v_pk_fma_f32 v[104:105], v[104:105], v[72:73], v[104:105]
    v_pk_fma_f32 v[110:111], v[108:109], v[72:73], v[108:109]
    v_pk_fma_f32 v[104:105], v[56:57], v[108:109], v[104:105]
    v_pk_fma_f32 v[104:105], v[104:105], v[74:75], v[104:105]
    v_pk_fma_f32 v[112:113], v[110:111], v[74:75], v[110:111]
    v_pk_fma_f32 v[104:105], v[58:59], v[110:111], v[104:105]
    v_pk_fma_f32 v[104:105], v[104:105], v[76:77], v[104:105]
    v_pk_fma_f32 v[110:111], v[112:113], v[76:77], v[112:113]
    v_pk_fma_f32 v[104:105], v[60:61], v[112:113], v[104:105]
    v_pk_fma_f32 v[104:105], v[104:105], v[78:79], v[104:105]
    v_pk_fma_f32 v[112:113], v[110:111], v[78:79], v[110:111]
    v_pk_fma_f32 v[104:105], v[62:63], v[110:111], v[104:105]
    v_pk_fma_f32 v[104:105], v[104:105], v[80:81], v[104:105]
    v_pk_fma_f32 v[110:111], v[112:113], v[80:81], v[112:113]
    v_pk_fma_f32 v[104:105], v[64:65], v[112:113], v[104:105]
    v_pk_fma_f32 v[104:105], v[104:105], v[82:83], v[104:105]
    v_pk_fma_f32 v[112:113], v[110:111], v[82:83], v[110:111]
    v_pk_fma_f32 v[104:105], v[66:67], v[110:111], v[104:105]
    v_pk_fma_f32 v[104:105], v[104:105], v[84:85], v[104:105]
    v_pk_fma_f32 v[110:111], v[112:113], v[84:85], v[112:113]
    v_pk_fma_f32 v[104:105], v[68:69], v[112:113], v[104:105]
    v_pk_fma_f32 v[104:105], v[104:105], v[86:87], v[104:105]
    v_pk_fma_f32 v[108:109], v[110:111], v[86:87], v[110:111]
    v_pk_fma_f32 v[104:105], v[70:71], v[110:111], v[104:105]
    v_rcp_f32 v112, v108
    v_rcp_f32 v113, v109
    v_max3_f32 v118, v108, v109, v118
    v_pk_mul_f32 v[112:113], v[104:105], v[112:113]
    v_cvt_f64_f32 v[84:85], v112
    v_cvt_f64_f32 v[86:87], v113
L_done:
    ds_add_f64 v116, v[84:85] offset:0
    ds_add_f64 v117, v[86:87] offset:0
    s_mov_b32 s4, 0x7b800000
    v_cmp_ngt_f32 vcc, s4, v118
    v_mov_b32 v110, 0
    v_mov_b32 v111, 4
    s_mov_b64 exec, vcc
    ds_or_b32 v110, v111 offset:58440
    s_mov_b64 exec, -1
L_post:
    s_or_b32 s4, s2, s6
    s_cbranch_scc1 L_nox
    v_mov_b32 v8, 0
    v_mov_b32 v9, s13
    s_mov_b64 exec, 1
    buffer_store_dword v9, v8, s[28:31], 0 offen sc1
    s_mov_b64 exec, -1
L_nox:
    s_cmp_ge_u32 s6, 4
    s_cbranch_scc1 L_ewait
    s_setprio 3
    ds_read_b128 v[104:107], v3 offset:3072
    ds_read_b128 v[108:111], v3 offset:4096
    s_lshl_b32 s74, s6, 11
    s_mul_i32 s75, s6, 10752
    s_add_u32 s3, s8, s74
    s_waitcnt lgkmcnt(0)
    v_add_u32 v104, s74, v104
    v_xor_b32 v105, 64, v104
    ds_read_b128 v[8:11], v104 offset:49984
    ds_read_b128 v[12:15], v105 offset:49984
    v_add_u32 v111, s75, v110
    s_cmp_lt_u32 s6, 3
    s_cselect_b64 s[56:57], -1, 0xffff
    s_cselect_b64 s[58:59], -1, 0
    ds_read_b64_tr_b16 v[64:65], v108 offset:33600
    ds_read_b64_tr_b16 v[66:67], v108 offset:34112
    ds_read_b64_tr_b16 v[68:69], v108 offset:37696
    ds_read_b64_tr_b16 v[70:71], v108 offset:38208
    ds_read_b64_tr_b16 v[72:73], v108 offset:33632
    ds_read_b64_tr_b16 v[74:75], v108 offset:34144
    ds_read_b64_tr_b16 v[76:77], v108 offset:37728
    ds_read_b64_tr_b16 v[78:79], v108 offset:38240
    s_waitcnt lgkmcnt(0)
    ds_read_b64_tr_b16 v[80:81], v108 offset:33664
    ds_read_b64_tr_b16 v[82:83], v108 offset:34176
    ds_read_b64_tr_b16 v[84:85], v108 offset:37760
    ds_read_b64_tr_b16 v[86:87], v108 offset:38272
    ds_read_b64_tr_b16 v[88:89], v108 offset:33696
    ds_read_b64_tr_b16 v[90:91], v108 offset:34208
    ds_read_b64_tr_b16 v[92:93], v108 offset:37792
    ds_read_b64_tr_b16 v[94:95], v108 offset:38304
    s_waitcnt lgkmcnt(0)
    ds_read_b64_tr_b16 v[16:17], v109 offset:41792
    ds_read_b64_tr_b16 v[18:19], v109 offset:42816
    ds_read_b64_tr_b16 v[20:21], v109 offset:43840
    ds_read_b64_tr_b16 v[22:23], v109 offset:44864
    ds_read_b64_tr_b16 v[24:25], v109 offset:41824
    ds_read_b64_tr_b16 v[26:27], v109 offset:42848
    ds_read_b64_tr_b16 v[28:29], v109 offset:43872
    ds_read_b64_tr_b16 v[30:31], v109 offset:44896
    v_mfma_f32_16x16x32_bf16 v[48:51], v[8:11], v[64:67], 0
    v_mfma_f32_16x16x32_bf16 v[48:51], v[12:15], v[68:71], v[48:51]
    v_mfma_f32_16x16x32_bf16 v[52:55], v[8:11], v[72:75], 0
    v_mfma_f32_16x16x32_bf16 v[52:55], v[12:15], v[76:79], v[52:55]
    s_waitcnt lgkmcnt(0)
    ds_read_b64_tr_b16 v[32:33], v109 offset:41856
    ds_read_b64_tr_b16 v[34:35], v109 offset:42880
    ds_read_b64_tr_b16 v[36:37], v109 offset:43904
    ds_read_b64_tr_b16 v[38:39], v109 offset:44928
    ds_read_b64_tr_b16 v[40:41], v109 offset:41888
    ds_read_b64_tr_b16 v[42:43], v109 offset:42912
    ds_read_b64_tr_b16 v[44:45], v109 offset:43936
    ds_read_b64_tr_b16 v[46:47], v109 offset:44960
    v_mfma_f32_16x16x32_bf16 v[56:59], v[8:11], v[80:83], 0
    v_mfma_f32_16x16x32_bf16 v[56:59], v[12:15], v[84:87], v[56:59]
    v_mfma_f32_16x16x32_bf16 v[60:63], v[8:11], v[88:91], 0
    v_mfma_f32_16x16x32_bf16 v[60:63], v[12:15], v[92:95], v[60:63]
    s_waitcnt lgkmcnt(0)
    s_mov_b32 s4, 0xbfb8aa3b
    s_mov_b32 s5, s4
    v_mul_f32 v48, s4, v48
    v_mul_f32 v49, s4, v49
    v_mul_f32 v50, s4, v50
    v_mul_f32 v51, s4, v51
    v_mul_f32 v52, s4, v52
    v_mul_f32 v53, s4, v53
    v_mul_f32 v54, s4, v54
    v_mul_f32 v55, s4, v55
    v_mul_f32 v56, s4, v56
    v_mul_f32 v57, s4, v57
    v_mul_f32 v58, s4, v58
    v_mul_f32 v59, s4, v59
    v_mul_f32 v60, s4, v60
    v_mul_f32 v61, s4, v61
    v_mul_f32 v62, s4, v62
    v_mul_f32 v63, s4, v63
    s_barrier
    ds_read_b128 v[64:67], v111 offset:0
    ds_read_b128 v[68:71], v111 offset:64
    ds_read_b128 v[72:75], v111 offset:128
    ds_read_b128 v[76:79], v111 offset:192
    ds_read_b128 v[80:83], v111 offset:256
    ds_read_b128 v[84:87], v111 offset:320
    ds_read_b128 v[88:91], v111 offset:384
    ds_read_b128 v[92:95], v111 offset:448
    s_waitcnt lgkmcnt(7)
    v_cvt_f32_f64 v64, v[64:65]
    v_cvt_f32_f64 v66, v[66:67]
    v_cvt_pk_bf16_f32 v8, v64, v66
    s_waitcnt lgkmcnt(6)
    v_cvt_f32_f64 v68, v[68:69]
    v_cvt_f32_f64 v70, v[70:71]
    v_cvt_pk_bf16_f32 v9, v68, v70
    s_waitcnt lgkmcnt(5)
    v_cvt_f32_f64 v72, v[72:73]
    v_cvt_f32_f64 v74, v[74:75]
    v_cvt_pk_bf16_f32 v10, v72, v74
    s_waitcnt lgkmcnt(4)
    v_cvt_f32_f64 v76, v[76:77]
    v_cvt_f32_f64 v78, v[78:79]
    v_cvt_pk_bf16_f32 v11, v76, v78
    s_waitcnt lgkmcnt(3)
    v_cvt_f32_f64 v80, v[80:81]
    v_cvt_f32_f64 v82, v[82:83]
    v_cvt_pk_bf16_f32 v12, v80, v82
    v_mfma_f32_16x16x32_bf16 v[48:51], v[8:11], v[16:19], v[48:51]
    s_waitcnt lgkmcnt(2)
    v_cvt_f32_f64 v84, v[84:85]
    v_cvt_f32_f64 v86, v[86:87]
    v_cvt_pk_bf16_f32 v13, v84, v86
    v_mfma_f32_16x16x32_bf16 v[52:55], v[8:11], v[24:27], v[52:55]
    s_waitcnt lgkmcnt(1)
    v_cvt_f32_f64 v88, v[88:89]
    v_cvt_f32_f64 v90, v[90:91]
    v_cvt_pk_bf16_f32 v14, v88, v90
    v_mfma_f32_16x16x32_bf16 v[56:59], v[8:11], v[32:35], v[56:59]
    s_waitcnt lgkmcnt(0)
    v_cvt_f32_f64 v92, v[92:93]
    v_cvt_f32_f64 v94, v[94:95]
    v_cvt_pk_bf16_f32 v15, v92, v94
    v_mfma_f32_16x16x32_bf16 v[60:63], v[8:11], v[40:43], v[60:63]
    s_nop 0
    v_mfma_f32_16x16x32_bf16 v[48:51], v[12:15], v[20:23], v[48:51]
    v_mfma_f32_16x16x32_bf16 v[52:55], v[12:15], v[28:31], v[52:55]
    v_mfma_f32_16x16x32_bf16 v[56:59], v[12:15], v[36:39], v[56:59]
    v_mfma_f32_16x16x32_bf16 v[60:63], v[12:15], v[44:47], v[60:63]
    s_nop 4
    v_exp_f32 v64, v48
    v_exp_f32 v65, v49
    v_exp_f32 v66, v50
    v_exp_f32 v67, v51
    v_exp_f32 v68, v52
    v_exp_f32 v69, v53
    v_exp_f32 v70, v54
    v_exp_f32 v71, v55
    v_exp_f32 v72, v56
    v_exp_f32 v73, v57
    v_exp_f32 v74, v58
    v_exp_f32 v75, v59
    v_exp_f32 v76, v60
    v_exp_f32 v77, v61
    v_exp_f32 v78, v62
    v_exp_f32 v79, v63
    v_pk_fma_f32 v[64:65], v[64:65], s[4:5], s[4:5]
    v_pk_fma_f32 v[66:67], v[66:67], s[4:5], s[4:5]
    v_pk_fma_f32 v[68:69], v[68:69], s[4:5], s[4:5]
    v_pk_fma_f32 v[70:71], v[70:71], s[4:5], s[4:5]
    v_pk_fma_f32 v[72:73], v[72:73], s[4:5], s[4:5]
    v_pk_fma_f32 v[74:75], v[74:75], s[4:5], s[4:5]
    v_pk_fma_f32 v[76:77], v[76:77], s[4:5], s[4:5]
    v_pk_fma_f32 v[78:79], v[78:79], s[4:5], s[4:5]
    v_rcp_f32 v64, v64
    v_rcp_f32 v65, v65
    v_rcp_f32 v68, v68
    v_rcp_f32 v69, v69
    v_rcp_f32 v72, v72
    v_rcp_f32 v73, v73
    v_rcp_f32 v76, v76
    v_rcp_f32 v77, v77
    v_pk_mul_f32 v[64:65], v[64:65], v[48:49]
    v_pk_mul_f32 v[68:69], v[68:69], v[52:53]
    v_pk_mul_f32 v[72:73], v[72:73], v[56:57]
    v_pk_mul_f32 v[76:77], v[76:77], v[60:61]
    v_cvt_pk_bf16_f32 v8, v64, v68
    v_cvt_pk_bf16_f32 v9, v72, v76
    buffer_store_dwordx2 v[8:9], v106, s[44:47], s3 offen offset:0 sc1
    v_cvt_pk_bf16_f32 v10, v65, v69
    v_cvt_pk_bf16_f32 v11, v73, v77
    buffer_store_dwordx2 v[10:11], v106, s[44:47], s3 offen offset:128 sc1
    v_rcp_f32 v66, v66
    v_rcp_f32 v67, v67
    v_rcp_f32 v70, v70
    v_rcp_f32 v71, v71
    v_rcp_f32 v74, v74
    v_rcp_f32 v75, v75
    v_rcp_f32 v78, v78
    v_rcp_f32 v79, v79
    v_pk_mul_f32 v[66:67], v[66:67], v[50:51]
    v_pk_mul_f32 v[70:71], v[70:71], v[54:55]
    v_pk_mul_f32 v[74:75], v[74:75], v[58:59]
    v_pk_mul_f32 v[78:79], v[78:79], v[62:63]
    v_cvt_pk_bf16_f32 v12, v66, v70
    v_cvt_pk_bf16_f32 v13, v74, v78
    buffer_store_dwordx2 v[12:13], v106, s[44:47], s3 offen offset:256 sc1
    v_cvt_pk_bf16_f32 v14, v67, v71
    v_cvt_pk_bf16_f32 v15, v75, v79
    buffer_store_dwordx2 v[14:15], v106, s[44:47], s3 offen offset:384 sc1
    s_movk_i32 s4, 0x207
    v_mov_b32 v16, 0
    v_mov_b32 v17, 4
    v_cmp_class_f32 vcc, v48, s4
    s_and_b64 exec, vcc, s[56:57]
    ds_or_b32 v16, v17 offset:58440
    s_mov_b64 exec, -1
    v_cmp_class_f32 vcc, v49, s4
    s_and_b64 exec, vcc, s[58:59]
    ds_or_b32 v16, v17 offset:58440
    s_mov_b64 exec, -1
    v_cmp_class_f32 vcc, v50, s4
    s_and_b64 exec, vcc, s[58:59]
    ds_or_b32 v16, v17 offset:58440
    s_mov_b64 exec, -1
    v_cmp_class_f32 vcc, v51, s4
    s_and_b64 exec, vcc, s[58:59]
    ds_or_b32 v16, v17 offset:58440
    s_mov_b64 exec, -1
    s_branch L_chk
L_ewait:
    s_waitcnt lgkmcnt(0)
    s_barrier
    v_mov_b32 v16, 0
L_chk:
    s_waitcnt lgkmcnt(0)
    s_barrier
    ds_read_b32 v17, v16 offset:58440
    s_waitcnt lgkmcnt(0)
    v_readfirstlane_b32 s4, v17
    s_cmp_gt_u32 s4, s14
    s_cbranch_scc1 L_slow
L_end:
    s_endpgm
L_loader:
    s_load_dword s13, s[28:29], 0
    s_barrier
    s_cmp_lg_u32 s6, 15
    s_cbranch_scc1 L_ldw
    v_bfe_u32 v24, v2, 4, 2
    v_lshlrev_b32 v24, 4, v24
    v_xor_b32 v24, v24, v31
    v_xor_b32 v25, 64, v24
    s_mov_b32 m0, 49984
    s_add_u32 s4, s8, 0
    buffer_load_dwordx4 v24, s[32:35], s4 offen offset:0 lds
    buffer_load_dwordx4 v25, s[32:35], s4 offen offset:1024 lds
    buffer_load_dwordx4 v24, s[32:35], s4 offen offset:2048 lds
    buffer_load_dwordx4 v25, s[32:35], s4 offen offset:3072 lds
    s_mov_b32 m0, 54080
    s_add_u32 s4, s8, 4096
    buffer_load_dwordx4 v24, s[32:35], s4 offen offset:0 lds
    buffer_load_dwordx4 v25, s[32:35], s4 offen offset:1024 lds
    buffer_load_dwordx4 v24, s[32:35], s4 offen offset:2048 lds
    buffer_load_dwordx4 v25, s[32:35], s4 offen offset:3072 lds
    s_branch L_lddone
L_ldw:
    v_bfe_u32 v26, v2, 4, 1
    v_lshlrev_b32 v26, 5, v26
    v_xor_b32 v26, v26, v31
    v_xor_b32 v27, 64, v26
    s_sub_u32 s4, s6, 13
    s_lshl_b32 s4, s4, 13
    s_add_u32 m0, s4, 113152
    s_add_u32 s5, s4, 0
    buffer_load_dwordx4 v26, s[36:39], s5 offen offset:0 lds
    buffer_load_dwordx4 v27, s[36:39], s5 offen offset:1024 lds
    buffer_load_dwordx4 v26, s[36:39], s5 offen offset:2048 lds
    buffer_load_dwordx4 v27, s[36:39], s5 offen offset:3072 lds
    s_add_u32 m0, s4, 117248
    s_add_u32 s5, s4, 4096
    buffer_load_dwordx4 v26, s[36:39], s5 offen offset:0 lds
    buffer_load_dwordx4 v27, s[36:39], s5 offen offset:1024 lds
    buffer_load_dwordx4 v26, s[36:39], s5 offen offset:2048 lds
    buffer_load_dwordx4 v27, s[36:39], s5 offen offset:3072 lds
    s_add_u32 m0, s4, 121344
    s_add_u32 s5, s4, 8192
    buffer_load_dwordx4 v26, s[36:39], s5 offen offset:0 lds
L_lddone:
    s_barrier
    s_barrier
    ds_read_b128 v[112:115], v3 offset:3072
    s_add_u32 s48, s28, 4096
    s_addc_u32 s49, s29, 0
    s_mov_b32 s52, s48
    s_mov_b32 s53, s49
    s_or_b32 s49, s49, 0x80000000
    s_mov_b32 s50, 1605632
    s_mov_b32 s51, 0x00c00000
    s_mov_b32 s55, 0x20000
    s_mov_b32 s14, 0
    s_and_b32 s4, s6, 3
    s_bfe_u32 s3, s6, 0x10002
    s_lshl_b32 s63, s4, 11
    s_lshl_b32 s64, s3, 13
    s_add_u32 s64, s64, 113152
    s_mul_i32 s65, s4, 10752
    s_mov_b32 s62, 0xbfb8aa3b
    s_add_u32 s54, s8, 6272
    s_add_u32 s66, s8, s63
    s_waitcnt lgkmcnt(0)
    v_add_u32 v112, s63, v112
    v_add_u32 v113, s64, v113
    v_xor_b32 v116, 64, v112
    v_xor_b32 v117, 32, v113
    v_xor_b32 v118, 64, v113
    v_xor_b32 v119, 0x60, v113
    s_mul_i32 s13, s13, 0x9e3779b5
    s_add_u32 s13, s13, 0x7f4a7c15
    v_mov_b32 v28, s13
    ds_write_b32 v32, v28 offset:58448
    s_waitcnt vmcnt(0)
L_last:
    s_branch L_join
L_long:
    s_mov_b64 exec, -1
    s_waitcnt vmcnt(0)
L_lgf2:
    v_cmp_ne_u64 vcc, v[74:75], v[76:77]
    s_cbranch_vccz L_lgok
    buffer_load_dwordx2 v[76:77], v71, s[28:31], s24 offen sc1
    s_sub_u32 s3, s3, 1
    s_waitcnt vmcnt(0)
    s_cbranch_scc0 L_lgf2
    s_branch L_giveup
L_lgok:
    s_mov_b32 s26, 32
L_lgrnd:
    s_lshl_b32 s27, s26, 2
    s_add_u32 s32, s27, 9437184
    s_lshl_b32 s27, s27, 1
    s_add_u32 s33, s27, s12
    s_mov_b64 exec, -1
    v_sub_u32_dpp v82, v92, v91 row_newbcast:0 row_mask:0xf bank_mask:0xf
    v_cmp_lt_i32 s[34:35], s26, v82
    s_bcnt1_i32_b64 s4, s[34:35]
    s_cbranch_scc0 L_lgn0
    s_add_u32 s4, s4, s25
    s_cmp_gt_u32 s4, s21
    s_cbranch_scc1 L_lgfull
    s_mov_b64 exec, s[34:35]
    buffer_load_dword v83, v8, s[28:31], s32 offen
    buffer_load_dwordx2 v[84:85], v78, s[28:31], s33 offen
    v_mbcnt_lo_u32_b32 v86, s34, 0
    v_mbcnt_hi_u32_b32 v86, s35, v86
    v_add_lshl_u32 v86, v86, s25, 3
    s_mov_b32 s25, s4
    s_waitcnt vmcnt(0)
    v_lshrrev_b32 v82, 16, v83
    ds_add_rtn_u32 v87, v82, v20 offset:58176
    ds_write_b64 v86, v[84:85]
    v_and_b32 v83, 0xffff, v83
    s_waitcnt lgkmcnt(0)
    ds_write2st64_b32 v87, v83, v86 offset0:0 offset1:104
L_lgn0:
    s_mov_b64 exec, -1
    v_sub_u32_dpp v82, v92, v91 row_newbcast:4 row_mask:0xf bank_mask:0xf
    v_cmp_lt_i32 s[34:35], s26, v82
    s_bcnt1_i32_b64 s4, s[34:35]
    s_cbranch_scc0 L_lgn1
    s_add_u32 s4, s4, s25
    s_cmp_gt_u32 s4, s21
    s_cbranch_scc1 L_lgfull
    s_mov_b64 exec, s[34:35]
    buffer_load_dword v83, v9, s[28:31], s32 offen
    buffer_load_dwordx2 v[84:85], v79, s[28:31], s33 offen
    v_mbcnt_lo_u32_b32 v86, s34, 0
    v_mbcnt_hi_u32_b32 v86, s35, v86
    v_add_lshl_u32 v86, v86, s25, 3
    s_mov_b32 s25, s4
    s_waitcnt vmcnt(0)
    v_lshrrev_b32 v82, 16, v83
    ds_add_rtn_u32 v87, v82, v20 offset:58176
    ds_write_b64 v86, v[84:85]
    v_and_b32 v83, 0xffff, v83
    s_waitcnt lgkmcnt(0)
    ds_write2st64_b32 v87, v83, v86 offset0:0 offset1:104
L_lgn1:
    s_mov_b64 exec, -1
    v_sub_u32_dpp v82, v92, v91 row_newbcast:8 row_mask:0xf bank_mask:0xf
    v_cmp_lt_i32 s[34:35], s26, v82
    s_bcnt1_i32_b64 s4, s[34:35]
    s_cbranch_scc0 L_lgn2
    s_add_u32 s4, s4, s25
    s_cmp_gt_u32 s4, s21
    s_cbranch_scc1 L_lgfull
    s_mov_b64 exec, s[34:35]
    buffer_load_dword v83, v10, s[28:31], s32 offen
    buffer_load_dwordx2 v[84:85], v80, s[28:31], s33 offen
    v_mbcnt_lo_u32_b32 v86, s34, 0
    v_mbcnt_hi_u32_b32 v86, s35, v86
    v_add_lshl_u32 v86, v86, s25, 3
    s_mov_b32 s25, s4
    s_waitcnt vmcnt(0)
    v_lshrrev_b32 v82, 16, v83
    ds_add_rtn_u32 v87, v82, v20 offset:58176
    ds_write_b64 v86, v[84:85]
    v_and_b32 v83, 0xffff, v83
    s_waitcnt lgkmcnt(0)
    ds_write2st64_b32 v87, v83, v86 offset0:0 offset1:104
L_lgn2:
    s_mov_b64 exec, -1
    v_sub_u32_dpp v82, v92, v91 row_newbcast:12 row_mask:0xf bank_mask:0xf
    v_cmp_lt_i32 s[34:35], s26, v82
    s_bcnt1_i32_b64 s4, s[34:35]
    s_cbranch_scc0 L_lgn3
    s_add_u32 s4, s4, s25
    s_cmp_gt_u32 s4, s21
    s_cbranch_scc1 L_lgfull
    s_mov_b64 exec, s[34:35]
    buffer_load_dword v83, v11, s[28:31], s32 offen
    buffer_load_dwordx2 v[84:85], v81, s[28:31], s33 offen
    v_mbcnt_lo_u32_b32 v86, s34, 0
    v_mbcnt_hi_u32_b32 v86, s35, v86
    v_add_lshl_u32 v86, v86, s25, 3
    s_mov_b32 s25, s4
    s_waitcnt vmcnt(0)
    v_lshrrev_b32 v82, 16, v83
    ds_add_rtn_u32 v87, v82, v20 offset:58176
    ds_write_b64 v86, v[84:85]
    v_and_b32 v83, 0xffff, v83
    s_waitcnt lgkmcnt(0)
    ds_write2st64_b32 v87, v83, v86 offset0:0 offset1:104
L_lgn3:
    s_mov_b64 exec, -1
    s_add_u32 s26, s26, 16
    v_cmp_lt_u32 vcc, s26, v92
    s_cbranch_vccnz L_lgrnd
    s_branch L_longdone
L_lgfull:
    ds_or_b32 v19, v20 offset:58440
    s_waitcnt lgkmcnt(0)
    s_branch L_longdone
L_zero:
    s_cmp_ge_u32 s6, 4
    s_cbranch_scc1 L_post
    s_waitcnt vmcnt(0)
    s_mov_b64 exec, s[64:65]
    ds_write_b64 v43, v[40:41]
    s_mov_b64 exec, s[66:67]
    ds_write_b64 v47, v[44:45]
    s_mov_b64 exec, s[68:69]
    ds_write_b64 v51, v[48:49]
    s_mov_b64 exec, s[70:71]
    ds_write_b64 v55, v[52:53]
    s_mov_b64 exec, -1
    s_waitcnt lgkmcnt(0)
    s_barrier
    s_branch L_post
L_slow:
    s_bitcmp1_b32 s4, 3
    s_cbranch_scc1 L_end
    s_mov_b32 s14, 4
    s_setprio 0
    s_mov_b64 exec, -1
    v_lshrrev_b32 v8, 2, v0
    v_lshlrev_b32 v8, 7, v8
    v_mov_b32 v10, s13
    v_not_b32 v11, v10
    s_mov_b32 s4, 7340032
    s_mov_b32 s3, 0x100000
L_sf2:
    buffer_load_dwordx2 v[12:13], v8, s[28:31], s4 offen sc1
    s_sub_u32 s3, s3, 1
    s_cbranch_scc1 L_end
    s_waitcnt vmcnt(0)
    v_cmp_ne_u64 vcc, v[10:11], v[12:13]
    s_cbranch_vccnz L_sf2
    s_waitcnt vmcnt(0) lgkmcnt(0)
    s_barrier
    v_lshrrev_b32 v10, 4, v0
    v_cmp_gt_u32 vcc, 50, v10
    v_mul_u32_u24 v10, 672, v10
    v_and_b32 v12, 15, v0
    v_lshl_add_u32 v10, v12, 5, v10
    v_mov_b32 v12, 0
    v_mov_b32 v13, 0
    v_mov_b32 v14, 0
    v_mov_b32 v15, 0
    v_and_b32 v6, 1, v2
    v_lshrrev_b32 v9, 5, v2
    v_lshl_add_u32 v6, v6, 1, v9
    v_bfe_u32 v7, v2, 1, 4
    v_lshl_add_u32 v6, v6, 4, v7
    v_lshlrev_b32 v6, 1, v6
    s_movk_i32 s5, 16384
    s_mov_b64 exec, vcc
    ds_write_b128 v10, v[12:15]
    ds_write_b128 v10, v[12:15] offset:16
    s_mov_b64 exec, -1
    buffer_load_ushort v16, v6, s[36:39], s5 offen offset:0
    buffer_load_ushort v17, v6, s[36:39], s5 offen offset:128
    buffer_load_ushort v18, v6, s[36:39], s5 offen offset:256
    buffer_load_ushort v19, v6, s[36:39], s5 offen offset:384
    s_mov_b32 s4, 0xbfb8aa3b
    s_waitcnt vmcnt(0) lgkmcnt(0)
    s_barrier
    v_lshlrev_b32 v16, 16, v16
    v_mul_f32 v16, s4, v16
    v_lshlrev_b32 v17, 16, v17
    v_mul_f32 v17, s4, v17
    v_lshlrev_b32 v18, 16, v18
    v_mul_f32 v18, s4, v18
    v_lshlrev_b32 v19, 16, v19
    v_mul_f32 v19, s4, v19
    v_and_b32 v6, 31, v2
    v_lshl_add_u32 v6, v6, 1, v9
    v_lshlrev_b32 v6, 1, v6
    v_lshlrev_b32 v7, 1, v2
    v_lshlrev_b32 v8, 3, v2
    s_mov_b32 s56, s6
    s_movk_i32 s61, 168
    s_mov_b32 s62, 4096
L_sseg:
    s_and_b32 s57, s2, 7
    s_lshl_b32 s57, s57, 8
    s_add_u32 s57, s57, s56
    s_lshl_b32 s57, s57, 8
    s_bfe_u32 s58, s7, 0x10001
    s_lshl_b32 s58, s58, 7
    s_add_u32 s57, s57, s58
    s_bfe_u32 s58, s7, 0x30002
    s_lshl_b32 s58, s58, 4
    s_add_u32 s57, s57, s58
    s_and_b32 s58, s7, 1
    s_lshl_b32 s58, s58, 3
    s_add_u32 s57, s57, s58
    s_add_u32 s57, s57, 8388608
    buffer_load_dword v20, v12, s[28:31], s57 offen sc1
    s_waitcnt vmcnt(0)
    v_readfirstlane_b32 s58, v20
    s_lshr_b32 s59, s58, 16
    s_and_b32 s58, s58, 0xffff
    s_lshl_b32 s58, s58, 2
    s_lshl_b32 s63, s58, 1
    s_mul_i32 s60, s56, 37760
    s_add_u32 s58, s58, s60
    s_add_u32 s58, s58, 9437184
    s_add_u32 s63, s63, s60
    s_add_u32 s63, s63, 9449728
    s_cmp_eq_u32 s59, 0
    s_cbranch_scc1 L_snext
L_sedge:
    buffer_load_dword v22, v12, s[28:31], s58 offen sc1
    buffer_load_dwordx2 v[20:21], v12, s[28:31], s63 offen sc1
    s_waitcnt vmcnt(0)
    v_and_b32 v23, 0xffff, v22
    v_lshl_add_u32 v23, v23, 5, v6
    buffer_load_ushort v23, v23, s[28:31], s62 offen sc1
    v_lshrrev_b32 v22, 16, v22
    v_mad_u32_u24 v24, v22, s61, v7
    ds_read_u16 v25, v24 offset:512
    v_mad_u32_u24 v24, v22, s61, v8
    v_lshlrev_b32 v27, 16, v20
    v_and_b32 v20, 0xffff0000, v20
    v_lshlrev_b32 v28, 16, v21
    v_and_b32 v21, 0xffff0000, v21
    v_mul_f32 v27, v27, v16
    v_fmac_f32 v27, v20, v17
    v_fmac_f32 v27, v28, v18
    v_fmac_f32 v27, v21, v19
    s_waitcnt vmcnt(0) lgkmcnt(0)
    v_lshlrev_b32 v23, 16, v23
    v_lshlrev_b32 v25, 16, v25
    v_add_f32 v27, v27, v25
    v_add_f32 v27, v27, v23
    v_exp_f32 v28, v27
    s_add_u32 s58, s58, 4
    s_add_u32 s63, s63, 8
    v_add_f32 v28, 1.0, v28
    v_rcp_f32 v28, v28
    s_sub_u32 s59, s59, 1
    v_mul_f32 v28, v27, v28
    v_cvt_f64_f32 v[28:29], v28
    ds_add_f64 v24, v[28:29]
    s_cmp_lg_u32 s59, 0
    s_cbranch_scc1 L_sedge
L_snext:
    s_add_u32 s56, s56, 16
    s_cmp_lt_u32 s56, 256
    s_cbranch_scc1 L_sseg
    s_branch L_post
.section .rodata,"a"
.p2align 6
.amdhsa_kernel standalone__mpnn_edge_mlp__graph_kernel
  .amdhsa_next_free_vgpr 128
  .amdhsa_next_free_sgpr 102
  .amdhsa_accum_offset 128
  .amdhsa_group_segment_fixed_size 0
  .amdhsa_kernarg_size 72
  .amdhsa_user_sgpr_count 2
  .amdhsa_user_sgpr_kernarg_segment_ptr 1
  .amdhsa_system_sgpr_workgroup_id_x 1
.end_amdhsa_kernel
```
